```python
import torch

def _softmax(x, axis=-1):
    return torch.softmax(x, dim=axis)

def _gelu(x):
    return torch.nn.functional.gelu(x, approximate='tanh')

def _silu(x):
    return torch.nn.functional.silu(x)

def _sigmoid(x):
    return torch.sigmoid(x)

def _layernorm(x, axis=-1, eps=1e-05):
    m = x.mean(dim=axis, keepdim=True)
    v = x.var(dim=axis, keepdim=True, unbiased=False)
    return (x - m) / torch.sqrt(v + eps)

def _scatter_add(tgt, idx, src, axis=0):
    return tgt.clone().index_add_(axis, idx, src)

def _segment_sum(src, seg, n):
    out = torch.zeros((n,) + src.shape[1:], dtype=src.dtype)
    return out.index_add_(0, seg, src)

def _pad(x, pw):
    flat = tuple((v for pair in reversed(pw) for v in pair))
    return torch.nn.functional.pad(x, flat)
kernel_name = 'adaLN_cond__ssm_conv_s4d__dense_activation_silu__prompt'

def setup_inputs():

    _w = lambda a: (lambda t: t.to(torch.bfloat16) if t.is_floating_point() else t)(torch.as_tensor(a))

    def _A_setup():
        Bsz, L, D, N = (1, 2048, 576, 128)
        return {'u': _w((lambda *s: torch.randn(*s, dtype=torch.bfloat16) * 0.05)(Bsz, L, D)), 'log_A_real': _w((lambda *s: torch.randn(*s, dtype=torch.bfloat16) * 3.2)(D, N) * 0.5), 'A_imag': _w((lambda *s: torch.randn(*s, dtype=torch.bfloat16) * 0.05)(D, N) * 3.14), 'C_real': _w((lambda *s: torch.randn(*s, dtype=torch.bfloat16) * 0.2)(D, N) / N ** 0.5), 'C_imag': _w((lambda *s: torch.randn(*s, dtype=torch.bfloat16) * 0.2)(D, N) / N ** 0.5), 'log_dt': _w((lambda *s: torch.randn(*s, dtype=torch.bfloat16) * 0.05)(D) * 0.5 - 4.0), 'D_skip': _w((lambda *s: torch.randn(*s, dtype=torch.bfloat16) * 0.1)(D))}
    _A_in = _A_setup()

    def _B_setup():
        B, S, D, F = (1, 2048, 576, 4608)
        return {'x': _w((lambda *s: torch.randn(*s, dtype=torch.bfloat16) * 0.05)(B, S, D)), 'w1': _w((lambda *s: torch.randn(*s, dtype=torch.bfloat16) * 3.2)(D, F) * D ** (-0.5)), 'w2': _w((lambda *s: torch.randn(*s, dtype=torch.bfloat16) * 0.4)(F, D) * F ** (-0.5))}
    _B_in = _B_setup()
    return {'A_u': _A_in['u'], 'A_log_A_real': _A_in['log_A_real'], 'A_A_imag': _A_in['A_imag'], 'A_C_real': _A_in['C_real'], 'A_C_imag': _A_in['C_imag'], 'A_log_dt': _A_in['log_dt'], 'A_D_skip': _A_in['D_skip'], 'B_x': _B_in['x'], 'B_w1': _B_in['w1'], 'B_w2': _B_in['w2'], 'c': _w((lambda *s: torch.randn(*s, dtype=torch.bfloat16) * 0.2)(1, 576) * 8.0), 'w_mod': _w((lambda *s: torch.randn(*s, dtype=torch.bfloat16) * 0.2)(576, 6 * 576) * 576 ** (-0.5) * 8.0)}

def reference(A_u, A_log_A_real, A_A_imag, A_C_real, A_C_imag, A_log_dt, A_D_skip, B_x, B_w1, B_w2, c, w_mod):

    def _A_ref(u, log_A_real, A_imag, C_real, C_imag, log_dt, D_skip):
        L = u.shape[1]
        dt = torch.exp(log_dt)
        A = -torch.exp(log_A_real) + 1j * A_imag
        C = (C_real + 1j * C_imag) * dt[:, None]
        pos = (lambda x, dt: x.to(dt))(torch.arange(L), log_dt.dtype)
        P = torch.exp((A * dt[:, None])[:, :, None] * pos[None, None, :])
        K = 2.0 * torch.einsum('dn,dnl->dl', C, P).real
        L2 = 2 * L
        u_t = (lambda x, *d: x.permute(*d))(u, 0, 2, 1)
        Kf = (lambda x, *a, **k: torch.fft.rfft(x.float(), *a, **k))(K, L2)
        Uf = (lambda x, *a, **k: torch.fft.rfft(x.float(), *a, **k))(u_t, L2)
        y = (lambda x, *a, **k: torch.fft.irfft(x, *a, **k).to(torch.bfloat16))(Uf * Kf[None, :, :], L2)[:, :, :L]
        y = (lambda x, *d: x.permute(*d))(y, 0, 2, 1)
        return y + u * D_skip[None, None, :]

    def _B_ref(x, w1, w2):
        h = torch.einsum('bsd,df->bsf', x, w1)
        h = _silu(h)
        out = torch.einsum('bsf,fd->bsd', h, w2)
        return out
    x = A_u
    mod = (_silu(c) @ w_mod).reshape(c.shape[0], 6, 1, -1)
    sa, ca, ga, sb, cb, gb = (mod[:, 0].clone(), mod[:, 1].clone(), mod[:, 2].clone(), mod[:, 3].clone(), mod[:, 4].clone(), mod[:, 5].clone())
    h = _layernorm(x, axis=-1) * (1 + ca) + sa
    x = x + ga * _A_ref(h, A_log_A_real, A_A_imag, A_C_real, A_C_imag, A_log_dt, A_D_skip)
    h = _layernorm(x, axis=-1) * (1 + cb) + sb
    x = x + gb * _B_ref(h, B_w1, B_w2)
    return x
```

```asm
; @launch kernel=k1_kernel grid=(840,1,1) block=(256,1,1) lds=37888
; @launch kernel=k2_kernel grid=(720,1,1) block=(256,1,1) lds=40320
; @launch kernel=k3_kernel grid=(256,1,1) block=(768,1,1) lds=154240
; @launch kernel=k4_kernel grid=(576,1,1) block=(256,1,1) lds=0
.amdgcn_target "amdgcn-amd-amdhsa--gfx950"
.text
.globl k1_kernel
.p2align 8
.type k1_kernel,@function
k1_kernel:
    s_load_dwordx2 s[4:5], s[0:1], 112
    s_mov_b32 s3, s2
    s_cmp_lt_u32 s3, 576
    s_cbranch_scc1 K1_KG
    s_sub_u32 s3, s3, 576
    s_cmp_lt_u32 s3, 64
    s_cbranch_scc1 K1_LN
    s_sub_u32 s3, s3, 64
    s_cmp_lt_u32 s3, 54
    s_cbranch_scc1 K1_MOD
    s_sub_u32 s3, s3, 54
    s_cmp_lt_u32 s3, 2
    s_cbranch_scc1 K1_EXIT
    s_sub_u32 s3, s3, 2
    s_cmp_lt_u32 s3, 144
    s_cbranch_scc1 K1_W2
    s_sub_u32 s3, s3, 144
K1_EXIT:
    s_endpgm
K1_LN:
    s_load_dwordx2 s[6:7], s[0:1], 0
    s_lshl_b32 s20, s3, 5
    s_waitcnt lgkmcnt(0)
    s_mov_b32 s8, s6
    s_mov_b32 s9, s7
    s_mov_b32 s10, 0x240000
    s_mov_b32 s11, 0x00020000
    v_lshrrev_b32 v1, 3, v0
    v_and_b32 v2, 7, v0
    v_add_u32 v3, s20, v1
    v_mul_u32_u24 v3, 1152, v3
    v_lshl_add_u32 v3, v2, 4, v3
    buffer_load_dwordx4 v[8:11], v3, s[8:11], 0 offen offset:0 nt
    buffer_load_dwordx4 v[12:15], v3, s[8:11], 0 offen offset:128 nt
    buffer_load_dwordx4 v[16:19], v3, s[8:11], 0 offen offset:256 nt
    buffer_load_dwordx4 v[20:23], v3, s[8:11], 0 offen offset:384 nt
    buffer_load_dwordx4 v[24:27], v3, s[8:11], 0 offen offset:512 nt
    buffer_load_dwordx4 v[28:31], v3, s[8:11], 0 offen offset:640 nt
    buffer_load_dwordx4 v[32:35], v3, s[8:11], 0 offen offset:768 nt
    buffer_load_dwordx4 v[36:39], v3, s[8:11], 0 offen offset:896 nt
    buffer_load_dwordx4 v[40:43], v3, s[8:11], 0 offen offset:1024 nt
    v_mul_u32_u24 v4, 1184, v1
    v_lshl_add_u32 v4, v2, 4, v4
    s_add_u32 s12, s4, 0x100000
    s_addc_u32 s13, s5, 0
    s_mov_b32 s14, 0x240000
    s_mov_b32 s15, 0x00020000
    s_add_u32 s16, s4, 0x30000
    s_addc_u32 s17, s5, 0
    s_mov_b32 s18, 0xa000
    s_mov_b32 s19, 0x00020000
    v_and_b32 v116, 63, v0
    v_lshrrev_b32 v117, 6, v0
    v_lshrrev_b32 v118, 4, v116
    v_and_b32 v119, 15, v116
    v_lshrrev_b32 v120, 2, v119
    v_lshl_add_u32 v120, v118, 3, v120
    v_mul_u32_u24 v5, 1184, v120
    v_and_b32 v120, 3, v119
    v_lshl_add_u32 v5, v120, 3, v5
    v_mul_u32_u24 v120, 288, v117
    v_add_u32 v5, v5, v120
    v_mul_u32_u24 v6, 144, v117
    v_add_u32 v6, v6, v119
    v_lshlrev_b32 v6, 12, v6
    v_lshl_add_u32 v6, v118, 4, v6
    s_lshl_b32 s21, s20, 1
    v_add_u32 v6, s21, v6
    s_waitcnt vmcnt(0)
    ds_write_b128 v4, v[8:11] offset:0
    ds_write_b128 v4, v[12:15] offset:128
    ds_write_b128 v4, v[16:19] offset:256
    ds_write_b128 v4, v[20:23] offset:384
    ds_write_b128 v4, v[24:27] offset:512
    ds_write_b128 v4, v[28:31] offset:640
    ds_write_b128 v4, v[32:35] offset:768
    ds_write_b128 v4, v[36:39] offset:896
    ds_write_b128 v4, v[40:43] offset:1024
    v_lshlrev_b32 v44, 16, v8
    v_and_b32 v45, 0xffff0000, v8
    v_lshlrev_b32 v46, 16, v9
    v_and_b32 v47, 0xffff0000, v9
    v_lshlrev_b32 v48, 16, v10
    v_and_b32 v49, 0xffff0000, v10
    v_lshlrev_b32 v50, 16, v11
    v_and_b32 v51, 0xffff0000, v11
    v_lshlrev_b32 v52, 16, v12
    v_and_b32 v53, 0xffff0000, v12
    v_lshlrev_b32 v54, 16, v13
    v_and_b32 v55, 0xffff0000, v13
    v_lshlrev_b32 v56, 16, v14
    v_and_b32 v57, 0xffff0000, v14
    v_lshlrev_b32 v58, 16, v15
    v_and_b32 v59, 0xffff0000, v15
    v_lshlrev_b32 v60, 16, v16
    v_and_b32 v61, 0xffff0000, v16
    v_lshlrev_b32 v62, 16, v17
    v_and_b32 v63, 0xffff0000, v17
    v_lshlrev_b32 v64, 16, v18
    v_and_b32 v65, 0xffff0000, v18
    v_lshlrev_b32 v66, 16, v19
    v_and_b32 v67, 0xffff0000, v19
    v_lshlrev_b32 v68, 16, v20
    v_and_b32 v69, 0xffff0000, v20
    v_lshlrev_b32 v70, 16, v21
    v_and_b32 v71, 0xffff0000, v21
    v_lshlrev_b32 v72, 16, v22
    v_and_b32 v73, 0xffff0000, v22
    v_lshlrev_b32 v74, 16, v23
    v_and_b32 v75, 0xffff0000, v23
    v_lshlrev_b32 v76, 16, v24
    v_and_b32 v77, 0xffff0000, v24
    v_lshlrev_b32 v78, 16, v25
    v_and_b32 v79, 0xffff0000, v25
    v_lshlrev_b32 v80, 16, v26
    v_and_b32 v81, 0xffff0000, v26
    v_lshlrev_b32 v82, 16, v27
    v_and_b32 v83, 0xffff0000, v27
    v_lshlrev_b32 v84, 16, v28
    v_and_b32 v85, 0xffff0000, v28
    v_lshlrev_b32 v86, 16, v29
    v_and_b32 v87, 0xffff0000, v29
    v_lshlrev_b32 v88, 16, v30
    v_and_b32 v89, 0xffff0000, v30
    v_lshlrev_b32 v90, 16, v31
    v_and_b32 v91, 0xffff0000, v31
    v_lshlrev_b32 v92, 16, v32
    v_and_b32 v93, 0xffff0000, v32
    v_lshlrev_b32 v94, 16, v33
    v_and_b32 v95, 0xffff0000, v33
    v_lshlrev_b32 v96, 16, v34
    v_and_b32 v97, 0xffff0000, v34
    v_lshlrev_b32 v98, 16, v35
    v_and_b32 v99, 0xffff0000, v35
    v_lshlrev_b32 v100, 16, v36
    v_and_b32 v101, 0xffff0000, v36
    v_lshlrev_b32 v102, 16, v37
    v_and_b32 v103, 0xffff0000, v37
    v_lshlrev_b32 v104, 16, v38
    v_and_b32 v105, 0xffff0000, v38
    v_lshlrev_b32 v106, 16, v39
    v_and_b32 v107, 0xffff0000, v39
    v_lshlrev_b32 v108, 16, v40
    v_and_b32 v109, 0xffff0000, v40
    v_lshlrev_b32 v110, 16, v41
    v_and_b32 v111, 0xffff0000, v41
    v_lshlrev_b32 v112, 16, v42
    v_and_b32 v113, 0xffff0000, v42
    v_lshlrev_b32 v114, 16, v43
    v_and_b32 v115, 0xffff0000, v43
    s_waitcnt lgkmcnt(0)
    s_barrier
    ds_read_b64_tr_b16 v[8:9], v5 offset:0
    ds_read_b64_tr_b16 v[10:11], v5 offset:4736
    ds_read_b64_tr_b16 v[12:13], v5 offset:32
    ds_read_b64_tr_b16 v[14:15], v5 offset:4768
    ds_read_b64_tr_b16 v[16:17], v5 offset:64
    ds_read_b64_tr_b16 v[18:19], v5 offset:4800
    ds_read_b64_tr_b16 v[20:21], v5 offset:96
    ds_read_b64_tr_b16 v[22:23], v5 offset:4832
    ds_read_b64_tr_b16 v[24:25], v5 offset:128
    ds_read_b64_tr_b16 v[26:27], v5 offset:4864
    ds_read_b64_tr_b16 v[28:29], v5 offset:160
    ds_read_b64_tr_b16 v[30:31], v5 offset:4896
    ds_read_b64_tr_b16 v[32:33], v5 offset:192
    ds_read_b64_tr_b16 v[34:35], v5 offset:4928
    ds_read_b64_tr_b16 v[36:37], v5 offset:224
    ds_read_b64_tr_b16 v[38:39], v5 offset:4960
    ds_read_b64_tr_b16 v[40:41], v5 offset:256
    ds_read_b64_tr_b16 v[42:43], v5 offset:4992
    v_pk_add_f32 v[116:117], v[44:45], v[46:47]
    v_pk_add_f32 v[118:119], v[48:49], v[50:51]
    v_pk_add_f32 v[116:117], v[116:117], v[52:53]
    v_pk_add_f32 v[118:119], v[118:119], v[54:55]
    v_pk_add_f32 v[116:117], v[116:117], v[56:57]
    v_pk_add_f32 v[118:119], v[118:119], v[58:59]
    v_pk_add_f32 v[116:117], v[116:117], v[60:61]
    v_pk_add_f32 v[118:119], v[118:119], v[62:63]
    v_pk_add_f32 v[116:117], v[116:117], v[64:65]
    v_pk_add_f32 v[118:119], v[118:119], v[66:67]
    v_pk_add_f32 v[116:117], v[116:117], v[68:69]
    v_pk_add_f32 v[118:119], v[118:119], v[70:71]
    v_pk_add_f32 v[116:117], v[116:117], v[72:73]
    v_pk_add_f32 v[118:119], v[118:119], v[74:75]
    v_pk_add_f32 v[116:117], v[116:117], v[76:77]
    v_pk_add_f32 v[118:119], v[118:119], v[78:79]
    v_pk_add_f32 v[116:117], v[116:117], v[80:81]
    v_pk_add_f32 v[118:119], v[118:119], v[82:83]
    v_pk_add_f32 v[116:117], v[116:117], v[84:85]
    v_pk_add_f32 v[118:119], v[118:119], v[86:87]
    v_pk_add_f32 v[116:117], v[116:117], v[88:89]
    v_pk_add_f32 v[118:119], v[118:119], v[90:91]
    v_pk_add_f32 v[116:117], v[116:117], v[92:93]
    v_pk_add_f32 v[118:119], v[118:119], v[94:95]
    v_pk_add_f32 v[116:117], v[116:117], v[96:97]
    v_pk_add_f32 v[118:119], v[118:119], v[98:99]
    v_pk_add_f32 v[116:117], v[116:117], v[100:101]
    v_pk_add_f32 v[118:119], v[118:119], v[102:103]
    v_pk_add_f32 v[116:117], v[116:117], v[104:105]
    v_pk_add_f32 v[118:119], v[118:119], v[106:107]
    v_pk_add_f32 v[116:117], v[116:117], v[108:109]
    v_pk_add_f32 v[118:119], v[118:119], v[110:111]
    v_pk_add_f32 v[116:117], v[116:117], v[112:113]
    v_pk_add_f32 v[118:119], v[118:119], v[114:115]
    v_pk_add_f32 v[116:117], v[116:117], v[118:119]
    v_add_f32 v116, v116, v117
    s_waitcnt lgkmcnt(0)
    s_mov_b32 s22, 0
    buffer_store_dwordx4 v[8:11], v6, s[12:15], s22 offen
    s_mov_b32 s22, 65536
    buffer_store_dwordx4 v[12:15], v6, s[12:15], s22 offen
    s_mov_b32 s22, 131072
    buffer_store_dwordx4 v[16:19], v6, s[12:15], s22 offen
    s_mov_b32 s22, 196608
    buffer_store_dwordx4 v[20:23], v6, s[12:15], s22 offen
    s_mov_b32 s22, 262144
    buffer_store_dwordx4 v[24:27], v6, s[12:15], s22 offen
    s_mov_b32 s22, 327680
    buffer_store_dwordx4 v[28:31], v6, s[12:15], s22 offen
    s_mov_b32 s22, 393216
    buffer_store_dwordx4 v[32:35], v6, s[12:15], s22 offen
    s_mov_b32 s22, 458752
    buffer_store_dwordx4 v[36:39], v6, s[12:15], s22 offen
    s_mov_b32 s22, 524288
    buffer_store_dwordx4 v[40:43], v6, s[12:15], s22 offen
    v_add_f32_dpp v116, v116, v116 quad_perm:[1,0,3,2] row_mask:0xf bank_mask:0xf
    s_nop 1
    v_add_f32_dpp v116, v116, v116 quad_perm:[2,3,0,1] row_mask:0xf bank_mask:0xf
    s_nop 1
    v_add_f32_dpp v116, v116, v116 row_half_mirror row_mask:0xf bank_mask:0xf
    v_mul_f32 v116, 0x3ae38e39, v116
    v_sub_f32 v118, 0, v116
    v_pk_add_f32 v[124:125], v[44:45], v[118:119] op_sel_hi:[1,0]
    v_pk_add_f32 v[126:127], v[46:47], v[118:119] op_sel_hi:[1,0]
    v_pk_mul_f32 v[120:121], v[124:125], v[124:125]
    v_pk_mul_f32 v[122:123], v[126:127], v[126:127]
    v_pk_add_f32 v[124:125], v[48:49], v[118:119] op_sel_hi:[1,0]
    v_pk_add_f32 v[126:127], v[50:51], v[118:119] op_sel_hi:[1,0]
    v_pk_fma_f32 v[120:121], v[124:125], v[124:125], v[120:121]
    v_pk_fma_f32 v[122:123], v[126:127], v[126:127], v[122:123]
    v_pk_add_f32 v[124:125], v[52:53], v[118:119] op_sel_hi:[1,0]
    v_pk_add_f32 v[126:127], v[54:55], v[118:119] op_sel_hi:[1,0]
    v_pk_fma_f32 v[120:121], v[124:125], v[124:125], v[120:121]
    v_pk_fma_f32 v[122:123], v[126:127], v[126:127], v[122:123]
    v_pk_add_f32 v[124:125], v[56:57], v[118:119] op_sel_hi:[1,0]
    v_pk_add_f32 v[126:127], v[58:59], v[118:119] op_sel_hi:[1,0]
    v_pk_fma_f32 v[120:121], v[124:125], v[124:125], v[120:121]
    v_pk_fma_f32 v[122:123], v[126:127], v[126:127], v[122:123]
    v_pk_add_f32 v[124:125], v[60:61], v[118:119] op_sel_hi:[1,0]
    v_pk_add_f32 v[126:127], v[62:63], v[118:119] op_sel_hi:[1,0]
    v_pk_fma_f32 v[120:121], v[124:125], v[124:125], v[120:121]
    v_pk_fma_f32 v[122:123], v[126:127], v[126:127], v[122:123]
    v_pk_add_f32 v[124:125], v[64:65], v[118:119] op_sel_hi:[1,0]
    v_pk_add_f32 v[126:127], v[66:67], v[118:119] op_sel_hi:[1,0]
    v_pk_fma_f32 v[120:121], v[124:125], v[124:125], v[120:121]
    v_pk_fma_f32 v[122:123], v[126:127], v[126:127], v[122:123]
    v_pk_add_f32 v[124:125], v[68:69], v[118:119] op_sel_hi:[1,0]
    v_pk_add_f32 v[126:127], v[70:71], v[118:119] op_sel_hi:[1,0]
    v_pk_fma_f32 v[120:121], v[124:125], v[124:125], v[120:121]
    v_pk_fma_f32 v[122:123], v[126:127], v[126:127], v[122:123]
    v_pk_add_f32 v[124:125], v[72:73], v[118:119] op_sel_hi:[1,0]
    v_pk_add_f32 v[126:127], v[74:75], v[118:119] op_sel_hi:[1,0]
    v_pk_fma_f32 v[120:121], v[124:125], v[124:125], v[120:121]
    v_pk_fma_f32 v[122:123], v[126:127], v[126:127], v[122:123]
    v_pk_add_f32 v[124:125], v[76:77], v[118:119] op_sel_hi:[1,0]
    v_pk_add_f32 v[126:127], v[78:79], v[118:119] op_sel_hi:[1,0]
    v_pk_fma_f32 v[120:121], v[124:125], v[124:125], v[120:121]
    v_pk_fma_f32 v[122:123], v[126:127], v[126:127], v[122:123]
    v_pk_add_f32 v[124:125], v[80:81], v[118:119] op_sel_hi:[1,0]
    v_pk_add_f32 v[126:127], v[82:83], v[118:119] op_sel_hi:[1,0]
    v_pk_fma_f32 v[120:121], v[124:125], v[124:125], v[120:121]
    v_pk_fma_f32 v[122:123], v[126:127], v[126:127], v[122:123]
    v_pk_add_f32 v[124:125], v[84:85], v[118:119] op_sel_hi:[1,0]
    v_pk_add_f32 v[126:127], v[86:87], v[118:119] op_sel_hi:[1,0]
    v_pk_fma_f32 v[120:121], v[124:125], v[124:125], v[120:121]
    v_pk_fma_f32 v[122:123], v[126:127], v[126:127], v[122:123]
    v_pk_add_f32 v[124:125], v[88:89], v[118:119] op_sel_hi:[1,0]
    v_pk_add_f32 v[126:127], v[90:91], v[118:119] op_sel_hi:[1,0]
    v_pk_fma_f32 v[120:121], v[124:125], v[124:125], v[120:121]
    v_pk_fma_f32 v[122:123], v[126:127], v[126:127], v[122:123]
    v_pk_add_f32 v[124:125], v[92:93], v[118:119] op_sel_hi:[1,0]
    v_pk_add_f32 v[126:127], v[94:95], v[118:119] op_sel_hi:[1,0]
    v_pk_fma_f32 v[120:121], v[124:125], v[124:125], v[120:121]
    v_pk_fma_f32 v[122:123], v[126:127], v[126:127], v[122:123]
    v_pk_add_f32 v[124:125], v[96:97], v[118:119] op_sel_hi:[1,0]
    v_pk_add_f32 v[126:127], v[98:99], v[118:119] op_sel_hi:[1,0]
    v_pk_fma_f32 v[120:121], v[124:125], v[124:125], v[120:121]
    v_pk_fma_f32 v[122:123], v[126:127], v[126:127], v[122:123]
    v_pk_add_f32 v[124:125], v[100:101], v[118:119] op_sel_hi:[1,0]
    v_pk_add_f32 v[126:127], v[102:103], v[118:119] op_sel_hi:[1,0]
    v_pk_fma_f32 v[120:121], v[124:125], v[124:125], v[120:121]
    v_pk_fma_f32 v[122:123], v[126:127], v[126:127], v[122:123]
    v_pk_add_f32 v[124:125], v[104:105], v[118:119] op_sel_hi:[1,0]
    v_pk_add_f32 v[126:127], v[106:107], v[118:119] op_sel_hi:[1,0]
    v_pk_fma_f32 v[120:121], v[124:125], v[124:125], v[120:121]
    v_pk_fma_f32 v[122:123], v[126:127], v[126:127], v[122:123]
    v_pk_add_f32 v[124:125], v[108:109], v[118:119] op_sel_hi:[1,0]
    v_pk_add_f32 v[126:127], v[110:111], v[118:119] op_sel_hi:[1,0]
    v_pk_fma_f32 v[120:121], v[124:125], v[124:125], v[120:121]
    v_pk_fma_f32 v[122:123], v[126:127], v[126:127], v[122:123]
    v_pk_add_f32 v[124:125], v[112:113], v[118:119] op_sel_hi:[1,0]
    v_pk_add_f32 v[126:127], v[114:115], v[118:119] op_sel_hi:[1,0]
    v_pk_fma_f32 v[120:121], v[124:125], v[124:125], v[120:121]
    v_pk_fma_f32 v[122:123], v[126:127], v[126:127], v[122:123]
    v_pk_add_f32 v[120:121], v[120:121], v[122:123]
    v_add_f32 v120, v120, v121
    s_nop 1
    v_add_f32_dpp v120, v120, v120 quad_perm:[1,0,3,2] row_mask:0xf bank_mask:0xf
    s_nop 1
    v_add_f32_dpp v120, v120, v120 quad_perm:[2,3,0,1] row_mask:0xf bank_mask:0xf
    s_nop 1
    v_add_f32_dpp v120, v120, v120 row_half_mirror row_mask:0xf bank_mask:0xf
    v_mul_f32 v120, 0x3ae38e39, v120
    v_cvt_pk_bf16_f32 v120, v120, v120
    v_lshlrev_b32 v120, 16, v120
    v_add_f32 v120, 0x3727c5ac, v120
    v_cvt_pk_bf16_f32 v120, v120, v120
    v_lshlrev_b32 v120, 16, v120
    v_sqrt_f32 v120, v120
    s_nop 0
    v_cvt_pk_bf16_f32 v120, v116, v120
    v_lshlrev_b32 v121, 2, v1
    v_cmp_eq_u32 vcc, 0, v2
    s_lshl_b32 s21, s20, 2
    s_and_saveexec_b64 s[26:27], vcc
    buffer_store_dword v120, v121, s[16:19], s21 offen
    s_endpgm
K1_MOD:
    s_load_dwordx2 s[6:7], s[0:1], 88
    s_load_dwordx2 s[24:25], s[0:1], 80
    s_mov_b32 s23, s3
    s_lshl_b32 s23, s23, 7
    s_waitcnt lgkmcnt(0)
    s_mov_b32 s8, s6
    s_mov_b32 s9, s7
    s_mov_b32 s10, 0x3cc000
    s_mov_b32 s11, 0x00020000
    s_mov_b32 s12, s24
    s_mov_b32 s13, s25
    s_mov_b32 s14, 0x480
    s_mov_b32 s15, 0x00020000
    s_mov_b32 s16, s4
    s_mov_b32 s17, s5
    s_mov_b32 s18, 0x3600
    s_mov_b32 s19, 0x00020000
    v_lshrrev_b32 v1, 3, v0
    v_and_b32 v2, 7, v0
    v_lshlrev_b32 v3, 1, v1
    buffer_load_ushort v80, v3, s[12:15], 0 offen offset:0
    buffer_load_ushort v81, v3, s[12:15], 0 offen offset:64
    buffer_load_ushort v82, v3, s[12:15], 0 offen offset:128
    buffer_load_ushort v83, v3, s[12:15], 0 offen offset:192
    buffer_load_ushort v84, v3, s[12:15], 0 offen offset:256
    buffer_load_ushort v85, v3, s[12:15], 0 offen offset:320
    buffer_load_ushort v86, v3, s[12:15], 0 offen offset:384
    buffer_load_ushort v87, v3, s[12:15], 0 offen offset:448
    buffer_load_ushort v88, v3, s[12:15], 0 offen offset:512
    buffer_load_ushort v89, v3, s[12:15], 0 offen offset:576
    buffer_load_ushort v90, v3, s[12:15], 0 offen offset:640
    buffer_load_ushort v91, v3, s[12:15], 0 offen offset:704
    buffer_load_ushort v92, v3, s[12:15], 0 offen offset:768
    buffer_load_ushort v93, v3, s[12:15], 0 offen offset:832
    buffer_load_ushort v94, v3, s[12:15], 0 offen offset:896
    buffer_load_ushort v95, v3, s[12:15], 0 offen offset:960
    buffer_load_ushort v96, v3, s[12:15], 0 offen offset:1024
    buffer_load_ushort v97, v3, s[12:15], 0 offen offset:1088
    v_mul_u32_u24 v4, 6912, v1
    v_lshl_add_u32 v4, v2, 4, v4
    v_add_u32 v4, s23, v4
    s_mov_b32 s22, 0
    buffer_load_dwordx4 v[8:11], v4, s[8:11], s22 offen nt
    s_mov_b32 s22, 221184
    buffer_load_dwordx4 v[12:15], v4, s[8:11], s22 offen nt
    s_mov_b32 s22, 442368
    buffer_load_dwordx4 v[16:19], v4, s[8:11], s22 offen nt
    s_mov_b32 s22, 663552
    buffer_load_dwordx4 v[20:23], v4, s[8:11], s22 offen nt
    s_mov_b32 s22, 884736
    buffer_load_dwordx4 v[24:27], v4, s[8:11], s22 offen nt
    s_mov_b32 s22, 1105920
    buffer_load_dwordx4 v[28:31], v4, s[8:11], s22 offen nt
    s_mov_b32 s22, 1327104
    buffer_load_dwordx4 v[32:35], v4, s[8:11], s22 offen nt
    s_mov_b32 s22, 1548288
    buffer_load_dwordx4 v[36:39], v4, s[8:11], s22 offen nt
    s_mov_b32 s22, 1769472
    buffer_load_dwordx4 v[40:43], v4, s[8:11], s22 offen nt
    s_mov_b32 s22, 1990656
    buffer_load_dwordx4 v[44:47], v4, s[8:11], s22 offen nt
    s_mov_b32 s22, 2211840
    buffer_load_dwordx4 v[48:51], v4, s[8:11], s22 offen nt
    s_mov_b32 s22, 2433024
    buffer_load_dwordx4 v[52:55], v4, s[8:11], s22 offen nt
    s_mov_b32 s22, 2654208
    buffer_load_dwordx4 v[56:59], v4, s[8:11], s22 offen nt
    s_mov_b32 s22, 2875392
    buffer_load_dwordx4 v[60:63], v4, s[8:11], s22 offen nt
    s_mov_b32 s22, 3096576
    buffer_load_dwordx4 v[64:67], v4, s[8:11], s22 offen nt
    s_mov_b32 s22, 3317760
    buffer_load_dwordx4 v[68:71], v4, s[8:11], s22 offen nt
    s_mov_b32 s22, 3538944
    buffer_load_dwordx4 v[72:75], v4, s[8:11], s22 offen nt
    s_mov_b32 s22, 3760128
    buffer_load_dwordx4 v[76:79], v4, s[8:11], s22 offen nt
    s_waitcnt vmcnt(18)
    v_lshlrev_b32 v80, 16, v80
    v_mul_f32 v100, 0xbfb8aa3b, v80
    v_exp_f32 v100, v100
    s_nop 0
    v_add_f32 v100, 1.0, v100
    v_rcp_f32 v100, v100
    s_nop 0
    v_mul_f32 v80, v80, v100
    v_cvt_pk_bf16_f32 v80, v80, v80
    v_lshlrev_b32 v80, 16, v80
    v_lshlrev_b32 v81, 16, v81
    v_mul_f32 v100, 0xbfb8aa3b, v81
    v_exp_f32 v100, v100
    s_nop 0
    v_add_f32 v100, 1.0, v100
    v_rcp_f32 v100, v100
    s_nop 0
    v_mul_f32 v81, v81, v100
    v_cvt_pk_bf16_f32 v81, v81, v81
    v_lshlrev_b32 v81, 16, v81
    v_lshlrev_b32 v82, 16, v82
    v_mul_f32 v100, 0xbfb8aa3b, v82
    v_exp_f32 v100, v100
    s_nop 0
    v_add_f32 v100, 1.0, v100
    v_rcp_f32 v100, v100
    s_nop 0
    v_mul_f32 v82, v82, v100
    v_cvt_pk_bf16_f32 v82, v82, v82
    v_lshlrev_b32 v82, 16, v82
    v_lshlrev_b32 v83, 16, v83
    v_mul_f32 v100, 0xbfb8aa3b, v83
    v_exp_f32 v100, v100
    s_nop 0
    v_add_f32 v100, 1.0, v100
    v_rcp_f32 v100, v100
    s_nop 0
    v_mul_f32 v83, v83, v100
    v_cvt_pk_bf16_f32 v83, v83, v83
    v_lshlrev_b32 v83, 16, v83
    v_lshlrev_b32 v84, 16, v84
    v_mul_f32 v100, 0xbfb8aa3b, v84
    v_exp_f32 v100, v100
    s_nop 0
    v_add_f32 v100, 1.0, v100
    v_rcp_f32 v100, v100
    s_nop 0
    v_mul_f32 v84, v84, v100
    v_cvt_pk_bf16_f32 v84, v84, v84
    v_lshlrev_b32 v84, 16, v84
    v_lshlrev_b32 v85, 16, v85
    v_mul_f32 v100, 0xbfb8aa3b, v85
    v_exp_f32 v100, v100
    s_nop 0
    v_add_f32 v100, 1.0, v100
    v_rcp_f32 v100, v100
    s_nop 0
    v_mul_f32 v85, v85, v100
    v_cvt_pk_bf16_f32 v85, v85, v85
    v_lshlrev_b32 v85, 16, v85
    v_lshlrev_b32 v86, 16, v86
    v_mul_f32 v100, 0xbfb8aa3b, v86
    v_exp_f32 v100, v100
    s_nop 0
    v_add_f32 v100, 1.0, v100
    v_rcp_f32 v100, v100
    s_nop 0
    v_mul_f32 v86, v86, v100
    v_cvt_pk_bf16_f32 v86, v86, v86
    v_lshlrev_b32 v86, 16, v86
    v_lshlrev_b32 v87, 16, v87
    v_mul_f32 v100, 0xbfb8aa3b, v87
    v_exp_f32 v100, v100
    s_nop 0
    v_add_f32 v100, 1.0, v100
    v_rcp_f32 v100, v100
    s_nop 0
    v_mul_f32 v87, v87, v100
    v_cvt_pk_bf16_f32 v87, v87, v87
    v_lshlrev_b32 v87, 16, v87
    v_lshlrev_b32 v88, 16, v88
    v_mul_f32 v100, 0xbfb8aa3b, v88
    v_exp_f32 v100, v100
    s_nop 0
    v_add_f32 v100, 1.0, v100
    v_rcp_f32 v100, v100
    s_nop 0
    v_mul_f32 v88, v88, v100
    v_cvt_pk_bf16_f32 v88, v88, v88
    v_lshlrev_b32 v88, 16, v88
    v_lshlrev_b32 v89, 16, v89
    v_mul_f32 v100, 0xbfb8aa3b, v89
    v_exp_f32 v100, v100
    s_nop 0
    v_add_f32 v100, 1.0, v100
    v_rcp_f32 v100, v100
    s_nop 0
    v_mul_f32 v89, v89, v100
    v_cvt_pk_bf16_f32 v89, v89, v89
    v_lshlrev_b32 v89, 16, v89
    v_lshlrev_b32 v90, 16, v90
    v_mul_f32 v100, 0xbfb8aa3b, v90
    v_exp_f32 v100, v100
    s_nop 0
    v_add_f32 v100, 1.0, v100
    v_rcp_f32 v100, v100
    s_nop 0
    v_mul_f32 v90, v90, v100
    v_cvt_pk_bf16_f32 v90, v90, v90
    v_lshlrev_b32 v90, 16, v90
    v_lshlrev_b32 v91, 16, v91
    v_mul_f32 v100, 0xbfb8aa3b, v91
    v_exp_f32 v100, v100
    s_nop 0
    v_add_f32 v100, 1.0, v100
    v_rcp_f32 v100, v100
    s_nop 0
    v_mul_f32 v91, v91, v100
    v_cvt_pk_bf16_f32 v91, v91, v91
    v_lshlrev_b32 v91, 16, v91
    v_lshlrev_b32 v92, 16, v92
    v_mul_f32 v100, 0xbfb8aa3b, v92
    v_exp_f32 v100, v100
    s_nop 0
    v_add_f32 v100, 1.0, v100
    v_rcp_f32 v100, v100
    s_nop 0
    v_mul_f32 v92, v92, v100
    v_cvt_pk_bf16_f32 v92, v92, v92
    v_lshlrev_b32 v92, 16, v92
    v_lshlrev_b32 v93, 16, v93
    v_mul_f32 v100, 0xbfb8aa3b, v93
    v_exp_f32 v100, v100
    s_nop 0
    v_add_f32 v100, 1.0, v100
    v_rcp_f32 v100, v100
    s_nop 0
    v_mul_f32 v93, v93, v100
    v_cvt_pk_bf16_f32 v93, v93, v93
    v_lshlrev_b32 v93, 16, v93
    v_lshlrev_b32 v94, 16, v94
    v_mul_f32 v100, 0xbfb8aa3b, v94
    v_exp_f32 v100, v100
    s_nop 0
    v_add_f32 v100, 1.0, v100
    v_rcp_f32 v100, v100
    s_nop 0
    v_mul_f32 v94, v94, v100
    v_cvt_pk_bf16_f32 v94, v94, v94
    v_lshlrev_b32 v94, 16, v94
    v_lshlrev_b32 v95, 16, v95
    v_mul_f32 v100, 0xbfb8aa3b, v95
    v_exp_f32 v100, v100
    s_nop 0
    v_add_f32 v100, 1.0, v100
    v_rcp_f32 v100, v100
    s_nop 0
    v_mul_f32 v95, v95, v100
    v_cvt_pk_bf16_f32 v95, v95, v95
    v_lshlrev_b32 v95, 16, v95
    v_lshlrev_b32 v96, 16, v96
    v_mul_f32 v100, 0xbfb8aa3b, v96
    v_exp_f32 v100, v100
    s_nop 0
    v_add_f32 v100, 1.0, v100
    v_rcp_f32 v100, v100
    s_nop 0
    v_mul_f32 v96, v96, v100
    v_cvt_pk_bf16_f32 v96, v96, v96
    v_lshlrev_b32 v96, 16, v96
    v_lshlrev_b32 v97, 16, v97
    v_mul_f32 v100, 0xbfb8aa3b, v97
    v_exp_f32 v100, v100
    s_nop 0
    v_add_f32 v100, 1.0, v100
    v_rcp_f32 v100, v100
    s_nop 0
    v_mul_f32 v97, v97, v100
    v_cvt_pk_bf16_f32 v97, v97, v97
    v_lshlrev_b32 v97, 16, v97
    v_mov_b32 v104, 0
    v_mov_b32 v105, 0
    v_mov_b32 v106, 0
    v_mov_b32 v107, 0
    v_mov_b32 v108, 0
    v_mov_b32 v109, 0
    v_mov_b32 v110, 0
    v_mov_b32 v111, 0
    s_waitcnt vmcnt(17)
    v_lshlrev_b32 v100, 16, v8
    v_and_b32 v101, 0xffff0000, v8
    v_fmac_f32 v104, v80, v100
    v_fmac_f32 v105, v80, v101
    v_lshlrev_b32 v100, 16, v9
    v_and_b32 v101, 0xffff0000, v9
    v_fmac_f32 v106, v80, v100
    v_fmac_f32 v107, v80, v101
    v_lshlrev_b32 v100, 16, v10
    v_and_b32 v101, 0xffff0000, v10
    v_fmac_f32 v108, v80, v100
    v_fmac_f32 v109, v80, v101
    v_lshlrev_b32 v100, 16, v11
    v_and_b32 v101, 0xffff0000, v11
    v_fmac_f32 v110, v80, v100
    v_fmac_f32 v111, v80, v101
    s_waitcnt vmcnt(16)
    v_lshlrev_b32 v100, 16, v12
    v_and_b32 v101, 0xffff0000, v12
    v_fmac_f32 v104, v81, v100
    v_fmac_f32 v105, v81, v101
    v_lshlrev_b32 v100, 16, v13
    v_and_b32 v101, 0xffff0000, v13
    v_fmac_f32 v106, v81, v100
    v_fmac_f32 v107, v81, v101
    v_lshlrev_b32 v100, 16, v14
    v_and_b32 v101, 0xffff0000, v14
    v_fmac_f32 v108, v81, v100
    v_fmac_f32 v109, v81, v101
    v_lshlrev_b32 v100, 16, v15
    v_and_b32 v101, 0xffff0000, v15
    v_fmac_f32 v110, v81, v100
    v_fmac_f32 v111, v81, v101
    s_waitcnt vmcnt(15)
    v_lshlrev_b32 v100, 16, v16
    v_and_b32 v101, 0xffff0000, v16
    v_fmac_f32 v104, v82, v100
    v_fmac_f32 v105, v82, v101
    v_lshlrev_b32 v100, 16, v17
    v_and_b32 v101, 0xffff0000, v17
    v_fmac_f32 v106, v82, v100
    v_fmac_f32 v107, v82, v101
    v_lshlrev_b32 v100, 16, v18
    v_and_b32 v101, 0xffff0000, v18
    v_fmac_f32 v108, v82, v100
    v_fmac_f32 v109, v82, v101
    v_lshlrev_b32 v100, 16, v19
    v_and_b32 v101, 0xffff0000, v19
    v_fmac_f32 v110, v82, v100
    v_fmac_f32 v111, v82, v101
    s_waitcnt vmcnt(14)
    v_lshlrev_b32 v100, 16, v20
    v_and_b32 v101, 0xffff0000, v20
    v_fmac_f32 v104, v83, v100
    v_fmac_f32 v105, v83, v101
    v_lshlrev_b32 v100, 16, v21
    v_and_b32 v101, 0xffff0000, v21
    v_fmac_f32 v106, v83, v100
    v_fmac_f32 v107, v83, v101
    v_lshlrev_b32 v100, 16, v22
    v_and_b32 v101, 0xffff0000, v22
    v_fmac_f32 v108, v83, v100
    v_fmac_f32 v109, v83, v101
    v_lshlrev_b32 v100, 16, v23
    v_and_b32 v101, 0xffff0000, v23
    v_fmac_f32 v110, v83, v100
    v_fmac_f32 v111, v83, v101
    s_waitcnt vmcnt(13)
    v_lshlrev_b32 v100, 16, v24
    v_and_b32 v101, 0xffff0000, v24
    v_fmac_f32 v104, v84, v100
    v_fmac_f32 v105, v84, v101
    v_lshlrev_b32 v100, 16, v25
    v_and_b32 v101, 0xffff0000, v25
    v_fmac_f32 v106, v84, v100
    v_fmac_f32 v107, v84, v101
    v_lshlrev_b32 v100, 16, v26
    v_and_b32 v101, 0xffff0000, v26
    v_fmac_f32 v108, v84, v100
    v_fmac_f32 v109, v84, v101
    v_lshlrev_b32 v100, 16, v27
    v_and_b32 v101, 0xffff0000, v27
    v_fmac_f32 v110, v84, v100
    v_fmac_f32 v111, v84, v101
    s_waitcnt vmcnt(12)
    v_lshlrev_b32 v100, 16, v28
    v_and_b32 v101, 0xffff0000, v28
    v_fmac_f32 v104, v85, v100
    v_fmac_f32 v105, v85, v101
    v_lshlrev_b32 v100, 16, v29
    v_and_b32 v101, 0xffff0000, v29
    v_fmac_f32 v106, v85, v100
    v_fmac_f32 v107, v85, v101
    v_lshlrev_b32 v100, 16, v30
    v_and_b32 v101, 0xffff0000, v30
    v_fmac_f32 v108, v85, v100
    v_fmac_f32 v109, v85, v101
    v_lshlrev_b32 v100, 16, v31
    v_and_b32 v101, 0xffff0000, v31
    v_fmac_f32 v110, v85, v100
    v_fmac_f32 v111, v85, v101
    s_waitcnt vmcnt(11)
    v_lshlrev_b32 v100, 16, v32
    v_and_b32 v101, 0xffff0000, v32
    v_fmac_f32 v104, v86, v100
    v_fmac_f32 v105, v86, v101
    v_lshlrev_b32 v100, 16, v33
    v_and_b32 v101, 0xffff0000, v33
    v_fmac_f32 v106, v86, v100
    v_fmac_f32 v107, v86, v101
    v_lshlrev_b32 v100, 16, v34
    v_and_b32 v101, 0xffff0000, v34
    v_fmac_f32 v108, v86, v100
    v_fmac_f32 v109, v86, v101
    v_lshlrev_b32 v100, 16, v35
    v_and_b32 v101, 0xffff0000, v35
    v_fmac_f32 v110, v86, v100
    v_fmac_f32 v111, v86, v101
    s_waitcnt vmcnt(10)
    v_lshlrev_b32 v100, 16, v36
    v_and_b32 v101, 0xffff0000, v36
    v_fmac_f32 v104, v87, v100
    v_fmac_f32 v105, v87, v101
    v_lshlrev_b32 v100, 16, v37
    v_and_b32 v101, 0xffff0000, v37
    v_fmac_f32 v106, v87, v100
    v_fmac_f32 v107, v87, v101
    v_lshlrev_b32 v100, 16, v38
    v_and_b32 v101, 0xffff0000, v38
    v_fmac_f32 v108, v87, v100
    v_fmac_f32 v109, v87, v101
    v_lshlrev_b32 v100, 16, v39
    v_and_b32 v101, 0xffff0000, v39
    v_fmac_f32 v110, v87, v100
    v_fmac_f32 v111, v87, v101
    s_waitcnt vmcnt(9)
    v_lshlrev_b32 v100, 16, v40
    v_and_b32 v101, 0xffff0000, v40
    v_fmac_f32 v104, v88, v100
    v_fmac_f32 v105, v88, v101
    v_lshlrev_b32 v100, 16, v41
    v_and_b32 v101, 0xffff0000, v41
    v_fmac_f32 v106, v88, v100
    v_fmac_f32 v107, v88, v101
    v_lshlrev_b32 v100, 16, v42
    v_and_b32 v101, 0xffff0000, v42
    v_fmac_f32 v108, v88, v100
    v_fmac_f32 v109, v88, v101
    v_lshlrev_b32 v100, 16, v43
    v_and_b32 v101, 0xffff0000, v43
    v_fmac_f32 v110, v88, v100
    v_fmac_f32 v111, v88, v101
    s_waitcnt vmcnt(8)
    v_lshlrev_b32 v100, 16, v44
    v_and_b32 v101, 0xffff0000, v44
    v_fmac_f32 v104, v89, v100
    v_fmac_f32 v105, v89, v101
    v_lshlrev_b32 v100, 16, v45
    v_and_b32 v101, 0xffff0000, v45
    v_fmac_f32 v106, v89, v100
    v_fmac_f32 v107, v89, v101
    v_lshlrev_b32 v100, 16, v46
    v_and_b32 v101, 0xffff0000, v46
    v_fmac_f32 v108, v89, v100
    v_fmac_f32 v109, v89, v101
    v_lshlrev_b32 v100, 16, v47
    v_and_b32 v101, 0xffff0000, v47
    v_fmac_f32 v110, v89, v100
    v_fmac_f32 v111, v89, v101
    s_waitcnt vmcnt(7)
    v_lshlrev_b32 v100, 16, v48
    v_and_b32 v101, 0xffff0000, v48
    v_fmac_f32 v104, v90, v100
    v_fmac_f32 v105, v90, v101
    v_lshlrev_b32 v100, 16, v49
    v_and_b32 v101, 0xffff0000, v49
    v_fmac_f32 v106, v90, v100
    v_fmac_f32 v107, v90, v101
    v_lshlrev_b32 v100, 16, v50
    v_and_b32 v101, 0xffff0000, v50
    v_fmac_f32 v108, v90, v100
    v_fmac_f32 v109, v90, v101
    v_lshlrev_b32 v100, 16, v51
    v_and_b32 v101, 0xffff0000, v51
    v_fmac_f32 v110, v90, v100
    v_fmac_f32 v111, v90, v101
    s_waitcnt vmcnt(6)
    v_lshlrev_b32 v100, 16, v52
    v_and_b32 v101, 0xffff0000, v52
    v_fmac_f32 v104, v91, v100
    v_fmac_f32 v105, v91, v101
    v_lshlrev_b32 v100, 16, v53
    v_and_b32 v101, 0xffff0000, v53
    v_fmac_f32 v106, v91, v100
    v_fmac_f32 v107, v91, v101
    v_lshlrev_b32 v100, 16, v54
    v_and_b32 v101, 0xffff0000, v54
    v_fmac_f32 v108, v91, v100
    v_fmac_f32 v109, v91, v101
    v_lshlrev_b32 v100, 16, v55
    v_and_b32 v101, 0xffff0000, v55
    v_fmac_f32 v110, v91, v100
    v_fmac_f32 v111, v91, v101
    s_waitcnt vmcnt(5)
    v_lshlrev_b32 v100, 16, v56
    v_and_b32 v101, 0xffff0000, v56
    v_fmac_f32 v104, v92, v100
    v_fmac_f32 v105, v92, v101
    v_lshlrev_b32 v100, 16, v57
    v_and_b32 v101, 0xffff0000, v57
    v_fmac_f32 v106, v92, v100
    v_fmac_f32 v107, v92, v101
    v_lshlrev_b32 v100, 16, v58
    v_and_b32 v101, 0xffff0000, v58
    v_fmac_f32 v108, v92, v100
    v_fmac_f32 v109, v92, v101
    v_lshlrev_b32 v100, 16, v59
    v_and_b32 v101, 0xffff0000, v59
    v_fmac_f32 v110, v92, v100
    v_fmac_f32 v111, v92, v101
    s_waitcnt vmcnt(4)
    v_lshlrev_b32 v100, 16, v60
    v_and_b32 v101, 0xffff0000, v60
    v_fmac_f32 v104, v93, v100
    v_fmac_f32 v105, v93, v101
    v_lshlrev_b32 v100, 16, v61
    v_and_b32 v101, 0xffff0000, v61
    v_fmac_f32 v106, v93, v100
    v_fmac_f32 v107, v93, v101
    v_lshlrev_b32 v100, 16, v62
    v_and_b32 v101, 0xffff0000, v62
    v_fmac_f32 v108, v93, v100
    v_fmac_f32 v109, v93, v101
    v_lshlrev_b32 v100, 16, v63
    v_and_b32 v101, 0xffff0000, v63
    v_fmac_f32 v110, v93, v100
    v_fmac_f32 v111, v93, v101
    s_waitcnt vmcnt(3)
    v_lshlrev_b32 v100, 16, v64
    v_and_b32 v101, 0xffff0000, v64
    v_fmac_f32 v104, v94, v100
    v_fmac_f32 v105, v94, v101
    v_lshlrev_b32 v100, 16, v65
    v_and_b32 v101, 0xffff0000, v65
    v_fmac_f32 v106, v94, v100
    v_fmac_f32 v107, v94, v101
    v_lshlrev_b32 v100, 16, v66
    v_and_b32 v101, 0xffff0000, v66
    v_fmac_f32 v108, v94, v100
    v_fmac_f32 v109, v94, v101
    v_lshlrev_b32 v100, 16, v67
    v_and_b32 v101, 0xffff0000, v67
    v_fmac_f32 v110, v94, v100
    v_fmac_f32 v111, v94, v101
    s_waitcnt vmcnt(2)
    v_lshlrev_b32 v100, 16, v68
    v_and_b32 v101, 0xffff0000, v68
    v_fmac_f32 v104, v95, v100
    v_fmac_f32 v105, v95, v101
    v_lshlrev_b32 v100, 16, v69
    v_and_b32 v101, 0xffff0000, v69
    v_fmac_f32 v106, v95, v100
    v_fmac_f32 v107, v95, v101
    v_lshlrev_b32 v100, 16, v70
    v_and_b32 v101, 0xffff0000, v70
    v_fmac_f32 v108, v95, v100
    v_fmac_f32 v109, v95, v101
    v_lshlrev_b32 v100, 16, v71
    v_and_b32 v101, 0xffff0000, v71
    v_fmac_f32 v110, v95, v100
    v_fmac_f32 v111, v95, v101
    s_waitcnt vmcnt(1)
    v_lshlrev_b32 v100, 16, v72
    v_and_b32 v101, 0xffff0000, v72
    v_fmac_f32 v104, v96, v100
    v_fmac_f32 v105, v96, v101
    v_lshlrev_b32 v100, 16, v73
    v_and_b32 v101, 0xffff0000, v73
    v_fmac_f32 v106, v96, v100
    v_fmac_f32 v107, v96, v101
    v_lshlrev_b32 v100, 16, v74
    v_and_b32 v101, 0xffff0000, v74
    v_fmac_f32 v108, v96, v100
    v_fmac_f32 v109, v96, v101
    v_lshlrev_b32 v100, 16, v75
    v_and_b32 v101, 0xffff0000, v75
    v_fmac_f32 v110, v96, v100
    v_fmac_f32 v111, v96, v101
    s_waitcnt vmcnt(0)
    v_lshlrev_b32 v100, 16, v76
    v_and_b32 v101, 0xffff0000, v76
    v_fmac_f32 v104, v97, v100
    v_fmac_f32 v105, v97, v101
    v_lshlrev_b32 v100, 16, v77
    v_and_b32 v101, 0xffff0000, v77
    v_fmac_f32 v106, v97, v100
    v_fmac_f32 v107, v97, v101
    v_lshlrev_b32 v100, 16, v78
    v_and_b32 v101, 0xffff0000, v78
    v_fmac_f32 v108, v97, v100
    v_fmac_f32 v109, v97, v101
    v_lshlrev_b32 v100, 16, v79
    v_and_b32 v101, 0xffff0000, v79
    v_fmac_f32 v110, v97, v100
    v_fmac_f32 v111, v97, v101
    v_lshlrev_b32 v5, 8, v1
    v_lshl_add_u32 v5, v2, 5, v5
    ds_write_b128 v5, v[104:107]
    ds_write_b128 v5, v[108:111] offset:16
    s_waitcnt lgkmcnt(0)
    s_barrier
    v_cmp_gt_u32 vcc, 64, v0
    s_nop 0
    s_and_saveexec_b64 s[26:27], vcc
    s_cbranch_execz K1_MOD_END
    v_lshlrev_b32 v5, 2, v0
    ds_read_b32 v8, v5 offset:0
    ds_read_b32 v9, v5 offset:256
    ds_read_b32 v10, v5 offset:512
    ds_read_b32 v11, v5 offset:768
    ds_read_b32 v12, v5 offset:1024
    ds_read_b32 v13, v5 offset:1280
    ds_read_b32 v14, v5 offset:1536
    ds_read_b32 v15, v5 offset:1792
    ds_read_b32 v16, v5 offset:2048
    ds_read_b32 v17, v5 offset:2304
    ds_read_b32 v18, v5 offset:2560
    ds_read_b32 v19, v5 offset:2816
    ds_read_b32 v20, v5 offset:3072
    ds_read_b32 v21, v5 offset:3328
    ds_read_b32 v22, v5 offset:3584
    ds_read_b32 v23, v5 offset:3840
    ds_read_b32 v24, v5 offset:4096
    ds_read_b32 v25, v5 offset:4352
    ds_read_b32 v26, v5 offset:4608
    ds_read_b32 v27, v5 offset:4864
    ds_read_b32 v28, v5 offset:5120
    ds_read_b32 v29, v5 offset:5376
    ds_read_b32 v30, v5 offset:5632
    ds_read_b32 v31, v5 offset:5888
    ds_read_b32 v32, v5 offset:6144
    ds_read_b32 v33, v5 offset:6400
    ds_read_b32 v34, v5 offset:6656
    ds_read_b32 v35, v5 offset:6912
    ds_read_b32 v36, v5 offset:7168
    ds_read_b32 v37, v5 offset:7424
    ds_read_b32 v38, v5 offset:7680
    ds_read_b32 v39, v5 offset:7936
    s_waitcnt lgkmcnt(0)
    v_add_f32 v8, v8, v24
    v_add_f32 v9, v9, v25
    v_add_f32 v10, v10, v26
    v_add_f32 v11, v11, v27
    v_add_f32 v12, v12, v28
    v_add_f32 v13, v13, v29
    v_add_f32 v14, v14, v30
    v_add_f32 v15, v15, v31
    v_add_f32 v16, v16, v32
    v_add_f32 v17, v17, v33
    v_add_f32 v18, v18, v34
    v_add_f32 v19, v19, v35
    v_add_f32 v20, v20, v36
    v_add_f32 v21, v21, v37
    v_add_f32 v22, v22, v38
    v_add_f32 v23, v23, v39
    v_add_f32 v8, v8, v16
    v_add_f32 v9, v9, v17
    v_add_f32 v10, v10, v18
    v_add_f32 v11, v11, v19
    v_add_f32 v12, v12, v20
    v_add_f32 v13, v13, v21
    v_add_f32 v14, v14, v22
    v_add_f32 v15, v15, v23
    v_add_f32 v8, v8, v12
    v_add_f32 v9, v9, v13
    v_add_f32 v10, v10, v14
    v_add_f32 v11, v11, v15
    v_add_f32 v8, v8, v10
    v_add_f32 v9, v9, v11
    v_add_f32 v8, v8, v9
    v_cvt_pk_bf16_f32 v8, v8, v8
    v_lshlrev_b32 v8, 16, v8
    s_lshl_b32 s23, s23, 1
    buffer_store_dword v8, v5, s[16:19], s23 offen
K1_MOD_END:
    s_endpgm
K1_KG:
    s_load_dwordx4 s[24:27], s[0:1], 8
    s_load_dwordx4 s[28:31], s[0:1], 24
    s_load_dwordx2 s[32:33], s[0:1], 40
    s_mov_b32 s23, s3
    s_lshl_b32 s22, s23, 1
    s_and_b32 s22, s22, 0xfffffffc
    v_and_b32 v1, 63, v0
    v_lshrrev_b32 v2, 4, v0
    v_lshlrev_b32 v3, 4, v2
    s_lshl_b32 s44, s23, 8
    s_waitcnt lgkmcnt(0)
    s_load_dword s34, s[32:33], s22
    s_mov_b32 s8, s24
    s_mov_b32 s9, s25
    s_mov_b32 s10, 0x24000
    s_mov_b32 s11, 0x00020000
    buffer_load_dwordx4 v[8:11], v3, s[8:11], s44 offen nt
    s_mov_b32 s12, s26
    s_mov_b32 s13, s27
    s_mov_b32 s14, 0x24000
    s_mov_b32 s15, 0x00020000
    buffer_load_dwordx4 v[12:15], v3, s[12:15], s44 offen nt
    s_mov_b32 s16, s28
    s_mov_b32 s17, s29
    s_mov_b32 s18, 0x24000
    s_mov_b32 s19, 0x00020000
    buffer_load_dwordx4 v[16:19], v3, s[16:19], s44 offen nt
    s_mov_b32 s36, s30
    s_mov_b32 s37, s31
    s_mov_b32 s38, 0x24000
    s_mov_b32 s39, 0x00020000
    buffer_load_dwordx4 v[20:23], v3, s[36:39], s44 offen nt
    s_add_u32 s40, s4, 0x700000
    s_addc_u32 s41, s5, 0
    s_mov_b32 s42, 0x249000
    s_mov_b32 s43, 0x00020000
    v_and_b32 v4, 15, v0
    v_lshrrev_b32 v112, 3, v4
    v_and_b32 v24, 7, v4
    v_lshl_add_u32 v24, v112, 7, v24
    v_cvt_f32_u32 v24, v24
    v_lshrrev_b32 v112, 2, v4
    v_and_b32 v26, 3, v4
    v_lshlrev_b32 v26, 1, v26
    v_lshl_add_u32 v26, v112, 7, v26
    v_add_u32 v26, 256, v26
    v_lshrrev_b32 v112, 1, v4
    v_lshlrev_b32 v112, 7, v112
    v_and_b32 v113, 1, v4
    v_lshl_add_u32 v112, v113, 2, v112
    v_cmp_gt_u32 vcc, 8, v4
    s_nop 1
    v_cndmask_b32 v26, v112, v26, vcc
    v_cvt_f32_u32 v26, v26
    v_lshlrev_b32 v28, 7, v4
    v_add_u32 v28, 1024, v28
    v_cvt_f32_u32 v28, v28
    v_lshlrev_b32 v30, 3, v4
    v_cvt_f32_u32 v30, v30
    v_mov_b32 v110, 0x41600000
    v_mov_b32 v111, 0
    v_lshlrev_b32 v5, 3, v0
    v_add_u32 v114, 0, v5
    v_cvt_f32_u32 v114, v114
    v_add_u32 v115, 1, v5
    v_cvt_f32_u32 v115, v115
    v_add_u32 v116, 2, v5
    v_cvt_f32_u32 v116, v116
    v_add_u32 v117, 3, v5
    v_cvt_f32_u32 v117, v117
    v_add_u32 v118, 4, v5
    v_cvt_f32_u32 v118, v118
    v_add_u32 v119, 5, v5
    v_cvt_f32_u32 v119, v119
    v_add_u32 v120, 6, v5
    v_cvt_f32_u32 v120, v120
    v_add_u32 v121, 7, v5
    v_cvt_f32_u32 v121, v121
    v_cvt_pk_bf16_f32 v114, v114, v115
    v_and_b32 v115, 0xffff0000, v114
    v_lshlrev_b32 v114, 16, v114
    v_cvt_pk_bf16_f32 v116, v116, v117
    v_and_b32 v117, 0xffff0000, v116
    v_lshlrev_b32 v116, 16, v116
    v_cvt_pk_bf16_f32 v118, v118, v119
    v_and_b32 v119, 0xffff0000, v118
    v_lshlrev_b32 v118, 16, v118
    v_cvt_pk_bf16_f32 v120, v120, v121
    v_and_b32 v121, 0xffff0000, v120
    v_lshlrev_b32 v120, 16, v120
    v_cvt_u32_f32 v114, v114
    v_lshlrev_b32 v114, 1, v114
    v_cvt_u32_f32 v115, v115
    v_lshlrev_b32 v115, 1, v115
    v_cvt_u32_f32 v116, v116
    v_lshlrev_b32 v116, 1, v116
    v_cvt_u32_f32 v117, v117
    v_lshlrev_b32 v117, 1, v117
    v_cvt_u32_f32 v118, v118
    v_lshlrev_b32 v118, 1, v118
    v_cvt_u32_f32 v119, v119
    v_lshlrev_b32 v119, 1, v119
    v_cvt_u32_f32 v120, v120
    v_lshlrev_b32 v120, 1, v120
    v_cvt_u32_f32 v121, v121
    v_lshlrev_b32 v121, 1, v121
    s_waitcnt lgkmcnt(0)
    s_and_b32 s22, s23, 1
    s_lshl_b32 s22, s22, 4
    s_lshr_b32 s34, s34, s22
    s_lshl_b32 s34, s34, 16
    v_mov_b32 v112, 0x3fb8aa3b
    v_mul_f32 v113, s34, v112
    v_exp_f32 v113, v113
    s_nop 0
    v_cvt_pk_bf16_f32 v113, v113, v113
    v_lshlrev_b32 v113, 16, v113
    v_mul_f32 v108, 0xbfb8aa3b, v113
    v_mul_f32 v109, 0x3e22f983, v113
    s_waitcnt vmcnt(0)
    v_lshlrev_b32 v32, 16, v8
    v_and_b32 v34, 0xffff0000, v8
    v_lshlrev_b32 v33, 16, v12
    v_and_b32 v35, 0xffff0000, v12
    v_lshlrev_b32 v48, 16, v16
    v_and_b32 v50, 0xffff0000, v16
    v_lshlrev_b32 v49, 16, v20
    v_and_b32 v51, 0xffff0000, v20
    v_lshlrev_b32 v36, 16, v9
    v_and_b32 v38, 0xffff0000, v9
    v_lshlrev_b32 v37, 16, v13
    v_and_b32 v39, 0xffff0000, v13
    v_lshlrev_b32 v52, 16, v17
    v_and_b32 v54, 0xffff0000, v17
    v_lshlrev_b32 v53, 16, v21
    v_and_b32 v55, 0xffff0000, v21
    v_lshlrev_b32 v40, 16, v10
    v_and_b32 v42, 0xffff0000, v10
    v_lshlrev_b32 v41, 16, v14
    v_and_b32 v43, 0xffff0000, v14
    v_lshlrev_b32 v56, 16, v18
    v_and_b32 v58, 0xffff0000, v18
    v_lshlrev_b32 v57, 16, v22
    v_and_b32 v59, 0xffff0000, v22
    v_lshlrev_b32 v44, 16, v11
    v_and_b32 v46, 0xffff0000, v11
    v_lshlrev_b32 v45, 16, v15
    v_and_b32 v47, 0xffff0000, v15
    v_lshlrev_b32 v60, 16, v19
    v_and_b32 v62, 0xffff0000, v19
    v_lshlrev_b32 v61, 16, v23
    v_and_b32 v63, 0xffff0000, v23
    v_mul_f32 v32, v112, v32
    v_exp_f32 v32, v32
    v_mul_f32 v34, v112, v34
    v_exp_f32 v34, v34
    v_mul_f32 v36, v112, v36
    v_exp_f32 v36, v36
    v_mul_f32 v38, v112, v38
    v_exp_f32 v38, v38
    v_mul_f32 v40, v112, v40
    v_exp_f32 v40, v40
    v_mul_f32 v42, v112, v42
    v_exp_f32 v42, v42
    v_mul_f32 v44, v112, v44
    v_exp_f32 v44, v44
    v_mul_f32 v46, v112, v46
    v_exp_f32 v46, v46
    v_max3_f32 v6, |v48|, |v49|, |v50|
    v_max3_f32 v6, |v51|, |v52|, v6
    v_max3_f32 v6, |v53|, |v54|, v6
    v_max3_f32 v6, |v55|, |v56|, v6
    v_max3_f32 v6, |v57|, |v58|, v6
    v_max3_f32 v6, |v59|, |v60|, v6
    v_max3_f32 v6, |v61|, |v62|, v6
    v_max_f32 v6, |v63|, v6
    v_cvt_pk_bf16_f32 v32, v32, v34
    v_and_b32 v34, 0xffff0000, v32
    v_lshlrev_b32 v32, 16, v32
    v_cvt_pk_bf16_f32 v36, v36, v38
    v_and_b32 v38, 0xffff0000, v36
    v_lshlrev_b32 v36, 16, v36
    v_cvt_pk_bf16_f32 v40, v40, v42
    v_and_b32 v42, 0xffff0000, v40
    v_lshlrev_b32 v40, 16, v40
    v_cvt_pk_bf16_f32 v44, v44, v46
    v_and_b32 v46, 0xffff0000, v44
    v_lshlrev_b32 v44, 16, v44
    v_readlane_b32 s48, v6, 0
    v_readlane_b32 s49, v6, 16
    v_readlane_b32 s50, v6, 32
    v_readlane_b32 s51, v6, 48
    v_pk_mul_f32 v[32:33], v[32:33], v[108:109]
    v_pk_mul_f32 v[34:35], v[34:35], v[108:109]
    v_pk_mul_f32 v[36:37], v[36:37], v[108:109]
    v_pk_mul_f32 v[38:39], v[38:39], v[108:109]
    v_pk_mul_f32 v[40:41], v[40:41], v[108:109]
    v_pk_mul_f32 v[42:43], v[42:43], v[108:109]
    v_pk_mul_f32 v[44:45], v[44:45], v[108:109]
    v_pk_mul_f32 v[46:47], v[46:47], v[108:109]
    s_max_u32 s48, s48, s49
    s_max_u32 s50, s50, s51
    s_max_u32 s48, s48, s50
    s_lshr_b32 s48, s48, 23
    s_max_u32 s48, s48, 13
    s_min_u32 s48, s48, 254
    s_sub_u32 s50, 267, s48
    s_lshl_b32 s50, s50, 23
    s_mov_b32 s51, s50
    s_sub_u32 s49, s48, 153
    v_pk_mul_f32 v[48:49], v[48:49], s[50:51]
    v_pk_mul_f32 v[50:51], v[50:51], s[50:51]
    v_pk_mul_f32 v[52:53], v[52:53], s[50:51]
    v_pk_mul_f32 v[54:55], v[54:55], s[50:51]
    v_pk_mul_f32 v[56:57], v[56:57], s[50:51]
    v_pk_mul_f32 v[58:59], v[58:59], s[50:51]
    v_pk_mul_f32 v[60:61], v[60:61], s[50:51]
    v_pk_mul_f32 v[62:63], v[62:63], s[50:51]
    v_ldexp_f32 v113, v113, s49
    v_pk_fma_f32 v[64:65], v[32:33], v[24:25], v[110:111] op_sel_hi:[1,0,1]
    v_pk_fma_f32 v[66:67], v[32:33], v[26:27], v[110:111] op_sel_hi:[1,0,1]
    v_pk_fma_f32 v[68:69], v[32:33], v[28:29], v[110:111] op_sel_hi:[1,0,1]
    v_pk_mul_f32 v[70:71], v[32:33], v[30:31] op_sel_hi:[1,0]
    v_fract_f32 v65, v65
    v_fract_f32 v67, v67
    v_fract_f32 v69, v69
    v_fract_f32 v71, v71
    v_exp_f32 v64, v64
    v_cos_f32 v72, v65
    v_sin_f32 v73, v65
    v_exp_f32 v66, v66
    v_cos_f32 v74, v67
    v_sin_f32 v75, v67
    v_exp_f32 v68, v68
    v_cos_f32 v76, v69
    v_sin_f32 v77, v69
    v_exp_f32 v70, v70
    v_cos_f32 v78, v71
    v_sin_f32 v79, v71
    v_pk_mul_f32 v[72:73], v[72:73], v[64:65] op_sel_hi:[1,0]
    v_pk_mul_f32 v[74:75], v[74:75], v[66:67] op_sel_hi:[1,0]
    v_pk_mul_f32 v[76:77], v[76:77], v[68:69] op_sel_hi:[1,0]
    v_pk_mul_f32 v[78:79], v[78:79], v[70:71] op_sel_hi:[1,0]
    v_cvt_pk_f16_f32 v80, v72, v73
    v_cvt_pk_f16_f32 v84, v74, v75
    v_cvt_pk_f16_f32 v88, v76, v77
    v_pk_mul_f32 v[64:65], v[78:79], v[48:49] op_sel_hi:[1,0] neg_hi:[1,0]
    v_pk_fma_f32 v[64:65], v[78:79], v[48:49], v[64:65] op_sel:[1,1,0] op_sel_hi:[0,1,1] neg_lo:[1,0,0] neg_hi:[1,0,0]
    v_cvt_pk_f16_f32 v92, v64, v65
    v_pk_fma_f32 v[64:65], v[34:35], v[24:25], v[110:111] op_sel_hi:[1,0,1]
    v_pk_fma_f32 v[66:67], v[34:35], v[26:27], v[110:111] op_sel_hi:[1,0,1]
    v_pk_fma_f32 v[68:69], v[34:35], v[28:29], v[110:111] op_sel_hi:[1,0,1]
    v_pk_mul_f32 v[70:71], v[34:35], v[30:31] op_sel_hi:[1,0]
    v_fract_f32 v65, v65
    v_fract_f32 v67, v67
    v_fract_f32 v69, v69
    v_fract_f32 v71, v71
    v_exp_f32 v64, v64
    v_cos_f32 v72, v65
    v_sin_f32 v73, v65
    v_exp_f32 v66, v66
    v_cos_f32 v74, v67
    v_sin_f32 v75, v67
    v_exp_f32 v68, v68
    v_cos_f32 v76, v69
    v_sin_f32 v77, v69
    v_exp_f32 v70, v70
    v_cos_f32 v78, v71
    v_sin_f32 v79, v71
    v_pk_mul_f32 v[72:73], v[72:73], v[64:65] op_sel_hi:[1,0]
    v_pk_mul_f32 v[74:75], v[74:75], v[66:67] op_sel_hi:[1,0]
    v_pk_mul_f32 v[76:77], v[76:77], v[68:69] op_sel_hi:[1,0]
    v_pk_mul_f32 v[78:79], v[78:79], v[70:71] op_sel_hi:[1,0]
    v_cvt_pk_f16_f32 v81, v72, v73
    v_cvt_pk_f16_f32 v85, v74, v75
    v_cvt_pk_f16_f32 v89, v76, v77
    v_pk_mul_f32 v[64:65], v[78:79], v[50:51] op_sel_hi:[1,0] neg_hi:[1,0]
    v_pk_fma_f32 v[64:65], v[78:79], v[50:51], v[64:65] op_sel:[1,1,0] op_sel_hi:[0,1,1] neg_lo:[1,0,0] neg_hi:[1,0,0]
    v_cvt_pk_f16_f32 v93, v64, v65
    v_pk_fma_f32 v[64:65], v[36:37], v[24:25], v[110:111] op_sel_hi:[1,0,1]
    v_pk_fma_f32 v[66:67], v[36:37], v[26:27], v[110:111] op_sel_hi:[1,0,1]
    v_pk_fma_f32 v[68:69], v[36:37], v[28:29], v[110:111] op_sel_hi:[1,0,1]
    v_pk_mul_f32 v[70:71], v[36:37], v[30:31] op_sel_hi:[1,0]
    v_fract_f32 v65, v65
    v_fract_f32 v67, v67
    v_fract_f32 v69, v69
    v_fract_f32 v71, v71
    v_exp_f32 v64, v64
    v_cos_f32 v72, v65
    v_sin_f32 v73, v65
    v_exp_f32 v66, v66
    v_cos_f32 v74, v67
    v_sin_f32 v75, v67
    v_exp_f32 v68, v68
    v_cos_f32 v76, v69
    v_sin_f32 v77, v69
    v_exp_f32 v70, v70
    v_cos_f32 v78, v71
    v_sin_f32 v79, v71
    v_pk_mul_f32 v[72:73], v[72:73], v[64:65] op_sel_hi:[1,0]
    v_pk_mul_f32 v[74:75], v[74:75], v[66:67] op_sel_hi:[1,0]
    v_pk_mul_f32 v[76:77], v[76:77], v[68:69] op_sel_hi:[1,0]
    v_pk_mul_f32 v[78:79], v[78:79], v[70:71] op_sel_hi:[1,0]
    v_cvt_pk_f16_f32 v82, v72, v73
    v_cvt_pk_f16_f32 v86, v74, v75
    v_cvt_pk_f16_f32 v90, v76, v77
    v_pk_mul_f32 v[64:65], v[78:79], v[52:53] op_sel_hi:[1,0] neg_hi:[1,0]
    v_pk_fma_f32 v[64:65], v[78:79], v[52:53], v[64:65] op_sel:[1,1,0] op_sel_hi:[0,1,1] neg_lo:[1,0,0] neg_hi:[1,0,0]
    v_cvt_pk_f16_f32 v94, v64, v65
    v_pk_fma_f32 v[64:65], v[38:39], v[24:25], v[110:111] op_sel_hi:[1,0,1]
    v_pk_fma_f32 v[66:67], v[38:39], v[26:27], v[110:111] op_sel_hi:[1,0,1]
    v_pk_fma_f32 v[68:69], v[38:39], v[28:29], v[110:111] op_sel_hi:[1,0,1]
    v_pk_mul_f32 v[70:71], v[38:39], v[30:31] op_sel_hi:[1,0]
    v_fract_f32 v65, v65
    v_fract_f32 v67, v67
    v_fract_f32 v69, v69
    v_fract_f32 v71, v71
    v_exp_f32 v64, v64
    v_cos_f32 v72, v65
    v_sin_f32 v73, v65
    v_exp_f32 v66, v66
    v_cos_f32 v74, v67
    v_sin_f32 v75, v67
    v_exp_f32 v68, v68
    v_cos_f32 v76, v69
    v_sin_f32 v77, v69
    v_exp_f32 v70, v70
    v_cos_f32 v78, v71
    v_sin_f32 v79, v71
    v_pk_mul_f32 v[72:73], v[72:73], v[64:65] op_sel_hi:[1,0]
    v_pk_mul_f32 v[74:75], v[74:75], v[66:67] op_sel_hi:[1,0]
    v_pk_mul_f32 v[76:77], v[76:77], v[68:69] op_sel_hi:[1,0]
    v_pk_mul_f32 v[78:79], v[78:79], v[70:71] op_sel_hi:[1,0]
    v_cvt_pk_f16_f32 v83, v72, v73
    v_cvt_pk_f16_f32 v87, v74, v75
    v_cvt_pk_f16_f32 v91, v76, v77
    v_pk_mul_f32 v[64:65], v[78:79], v[54:55] op_sel_hi:[1,0] neg_hi:[1,0]
    v_pk_fma_f32 v[64:65], v[78:79], v[54:55], v[64:65] op_sel:[1,1,0] op_sel_hi:[0,1,1] neg_lo:[1,0,0] neg_hi:[1,0,0]
    v_cvt_pk_f16_f32 v95, v64, v65
    s_nop 1
    v_mfma_f32_16x16x32_f16 v[96:99], v[80:83], v[92:95], 0
    v_mfma_f32_16x16x32_f16 v[100:103], v[84:87], v[92:95], 0
    v_mfma_f32_16x16x32_f16 v[104:107], v[88:91], v[92:95], 0
    v_pk_fma_f32 v[64:65], v[40:41], v[24:25], v[110:111] op_sel_hi:[1,0,1]
    v_pk_fma_f32 v[66:67], v[40:41], v[26:27], v[110:111] op_sel_hi:[1,0,1]
    v_pk_fma_f32 v[68:69], v[40:41], v[28:29], v[110:111] op_sel_hi:[1,0,1]
    v_pk_mul_f32 v[70:71], v[40:41], v[30:31] op_sel_hi:[1,0]
    v_fract_f32 v65, v65
    v_fract_f32 v67, v67
    v_fract_f32 v69, v69
    v_fract_f32 v71, v71
    v_exp_f32 v64, v64
    v_cos_f32 v72, v65
    v_sin_f32 v73, v65
    v_exp_f32 v66, v66
    v_cos_f32 v74, v67
    v_sin_f32 v75, v67
    v_exp_f32 v68, v68
    v_cos_f32 v76, v69
    v_sin_f32 v77, v69
    v_exp_f32 v70, v70
    v_cos_f32 v78, v71
    v_sin_f32 v79, v71
    v_pk_mul_f32 v[72:73], v[72:73], v[64:65] op_sel_hi:[1,0]
    v_pk_mul_f32 v[74:75], v[74:75], v[66:67] op_sel_hi:[1,0]
    v_pk_mul_f32 v[76:77], v[76:77], v[68:69] op_sel_hi:[1,0]
    v_pk_mul_f32 v[78:79], v[78:79], v[70:71] op_sel_hi:[1,0]
    v_cvt_pk_f16_f32 v80, v72, v73
    v_cvt_pk_f16_f32 v84, v74, v75
    v_cvt_pk_f16_f32 v88, v76, v77
    v_pk_mul_f32 v[64:65], v[78:79], v[56:57] op_sel_hi:[1,0] neg_hi:[1,0]
    v_pk_fma_f32 v[64:65], v[78:79], v[56:57], v[64:65] op_sel:[1,1,0] op_sel_hi:[0,1,1] neg_lo:[1,0,0] neg_hi:[1,0,0]
    v_cvt_pk_f16_f32 v92, v64, v65
    v_pk_fma_f32 v[64:65], v[42:43], v[24:25], v[110:111] op_sel_hi:[1,0,1]
    v_pk_fma_f32 v[66:67], v[42:43], v[26:27], v[110:111] op_sel_hi:[1,0,1]
    v_pk_fma_f32 v[68:69], v[42:43], v[28:29], v[110:111] op_sel_hi:[1,0,1]
    v_pk_mul_f32 v[70:71], v[42:43], v[30:31] op_sel_hi:[1,0]
    v_fract_f32 v65, v65
    v_fract_f32 v67, v67
    v_fract_f32 v69, v69
    v_fract_f32 v71, v71
    v_exp_f32 v64, v64
    v_cos_f32 v72, v65
    v_sin_f32 v73, v65
    v_exp_f32 v66, v66
    v_cos_f32 v74, v67
    v_sin_f32 v75, v67
    v_exp_f32 v68, v68
    v_cos_f32 v76, v69
    v_sin_f32 v77, v69
    v_exp_f32 v70, v70
    v_cos_f32 v78, v71
    v_sin_f32 v79, v71
    v_pk_mul_f32 v[72:73], v[72:73], v[64:65] op_sel_hi:[1,0]
    v_pk_mul_f32 v[74:75], v[74:75], v[66:67] op_sel_hi:[1,0]
    v_pk_mul_f32 v[76:77], v[76:77], v[68:69] op_sel_hi:[1,0]
    v_pk_mul_f32 v[78:79], v[78:79], v[70:71] op_sel_hi:[1,0]
    v_cvt_pk_f16_f32 v81, v72, v73
    v_cvt_pk_f16_f32 v85, v74, v75
    v_cvt_pk_f16_f32 v89, v76, v77
    v_pk_mul_f32 v[64:65], v[78:79], v[58:59] op_sel_hi:[1,0] neg_hi:[1,0]
    v_pk_fma_f32 v[64:65], v[78:79], v[58:59], v[64:65] op_sel:[1,1,0] op_sel_hi:[0,1,1] neg_lo:[1,0,0] neg_hi:[1,0,0]
    v_cvt_pk_f16_f32 v93, v64, v65
    v_pk_fma_f32 v[64:65], v[44:45], v[24:25], v[110:111] op_sel_hi:[1,0,1]
    v_pk_fma_f32 v[66:67], v[44:45], v[26:27], v[110:111] op_sel_hi:[1,0,1]
    v_pk_fma_f32 v[68:69], v[44:45], v[28:29], v[110:111] op_sel_hi:[1,0,1]
    v_pk_mul_f32 v[70:71], v[44:45], v[30:31] op_sel_hi:[1,0]
    v_fract_f32 v65, v65
    v_fract_f32 v67, v67
    v_fract_f32 v69, v69
    v_fract_f32 v71, v71
    v_exp_f32 v64, v64
    v_cos_f32 v72, v65
    v_sin_f32 v73, v65
    v_exp_f32 v66, v66
    v_cos_f32 v74, v67
    v_sin_f32 v75, v67
    v_exp_f32 v68, v68
    v_cos_f32 v76, v69
    v_sin_f32 v77, v69
    v_exp_f32 v70, v70
    v_cos_f32 v78, v71
    v_sin_f32 v79, v71
    v_pk_mul_f32 v[72:73], v[72:73], v[64:65] op_sel_hi:[1,0]
    v_pk_mul_f32 v[74:75], v[74:75], v[66:67] op_sel_hi:[1,0]
    v_pk_mul_f32 v[76:77], v[76:77], v[68:69] op_sel_hi:[1,0]
    v_pk_mul_f32 v[78:79], v[78:79], v[70:71] op_sel_hi:[1,0]
    v_cvt_pk_f16_f32 v82, v72, v73
    v_cvt_pk_f16_f32 v86, v74, v75
    v_cvt_pk_f16_f32 v90, v76, v77
    v_pk_mul_f32 v[64:65], v[78:79], v[60:61] op_sel_hi:[1,0] neg_hi:[1,0]
    v_pk_fma_f32 v[64:65], v[78:79], v[60:61], v[64:65] op_sel:[1,1,0] op_sel_hi:[0,1,1] neg_lo:[1,0,0] neg_hi:[1,0,0]
    v_cvt_pk_f16_f32 v94, v64, v65
    v_pk_fma_f32 v[64:65], v[46:47], v[24:25], v[110:111] op_sel_hi:[1,0,1]
    v_pk_fma_f32 v[66:67], v[46:47], v[26:27], v[110:111] op_sel_hi:[1,0,1]
    v_pk_fma_f32 v[68:69], v[46:47], v[28:29], v[110:111] op_sel_hi:[1,0,1]
    v_pk_mul_f32 v[70:71], v[46:47], v[30:31] op_sel_hi:[1,0]
    v_fract_f32 v65, v65
    v_fract_f32 v67, v67
    v_fract_f32 v69, v69
    v_fract_f32 v71, v71
    v_exp_f32 v64, v64
    v_cos_f32 v72, v65
    v_sin_f32 v73, v65
    v_exp_f32 v66, v66
    v_cos_f32 v74, v67
    v_sin_f32 v75, v67
    v_exp_f32 v68, v68
    v_cos_f32 v76, v69
    v_sin_f32 v77, v69
    v_exp_f32 v70, v70
    v_cos_f32 v78, v71
    v_sin_f32 v79, v71
    v_pk_mul_f32 v[72:73], v[72:73], v[64:65] op_sel_hi:[1,0]
    v_pk_mul_f32 v[74:75], v[74:75], v[66:67] op_sel_hi:[1,0]
    v_pk_mul_f32 v[76:77], v[76:77], v[68:69] op_sel_hi:[1,0]
    v_pk_mul_f32 v[78:79], v[78:79], v[70:71] op_sel_hi:[1,0]
    v_cvt_pk_f16_f32 v83, v72, v73
    v_cvt_pk_f16_f32 v87, v74, v75
    v_cvt_pk_f16_f32 v91, v76, v77
    v_pk_mul_f32 v[64:65], v[78:79], v[62:63] op_sel_hi:[1,0] neg_hi:[1,0]
    v_pk_fma_f32 v[64:65], v[78:79], v[62:63], v[64:65] op_sel:[1,1,0] op_sel_hi:[0,1,1] neg_lo:[1,0,0] neg_hi:[1,0,0]
    v_cvt_pk_f16_f32 v95, v64, v65
    s_nop 1
    v_mfma_f32_16x16x32_f16 v[96:99], v[80:83], v[92:95], v[96:99]
    v_mfma_f32_16x16x32_f16 v[100:103], v[84:87], v[92:95], v[100:103]
    v_mfma_f32_16x16x32_f16 v[104:107], v[88:91], v[92:95], v[104:107]
    v_lshrrev_b32 v5, 6, v0
    v_mul_u32_u24 v5, 3072, v5
    v_lshl_add_u32 v5, v1, 4, v5
    v_readfirstlane_b32 s45, v0
    s_nop 0
    s_lshr_b32 s45, s45, 6
    v_lshrrev_b32 v6, 4, v1
    v_lshlrev_b32 v6, 2, v6
    v_add_u32 v33, 1, v6
    v_add_u32 v34, 2, v6
    v_add_u32 v35, 3, v6
    v_mov_b32 v32, v6
    v_pk_mul_f32 v[96:97], v[96:97], v[112:113] op_sel:[0,1] op_sel_hi:[1,1]
    v_pk_mul_f32 v[98:99], v[98:99], v[112:113] op_sel:[0,1] op_sel_hi:[1,1]
    v_pk_mul_f32 v[100:101], v[100:101], v[112:113] op_sel:[0,1] op_sel_hi:[1,1]
    v_pk_mul_f32 v[102:103], v[102:103], v[112:113] op_sel:[0,1] op_sel_hi:[1,1]
    v_pk_mul_f32 v[104:105], v[104:105], v[112:113] op_sel:[0,1] op_sel_hi:[1,1]
    v_pk_mul_f32 v[106:107], v[106:107], v[112:113] op_sel:[0,1] op_sel_hi:[1,1]
    ds_write_b128 v5, v[96:99] offset:0
    ds_write_b128 v5, v[100:103] offset:1024
    ds_write_b128 v5, v[104:107] offset:2048
    s_cmp_lg_u32 s45, 0
    s_cbranch_scc1 K1_KG_T0
    v_lshrrev_b32 v40, 3, v32
    v_and_b32 v36, 7, v32
    v_lshl_add_u32 v36, v40, 7, v36
    v_lshrrev_b32 v40, 3, v33
    v_and_b32 v37, 7, v33
    v_lshl_add_u32 v37, v40, 7, v37
    v_lshrrev_b32 v40, 3, v34
    v_and_b32 v38, 7, v34
    v_lshl_add_u32 v38, v40, 7, v38
    v_lshrrev_b32 v40, 3, v35
    v_and_b32 v39, 7, v35
    v_lshl_add_u32 v39, v40, 7, v39
K1_KG_T0:
    s_cmp_lg_u32 s45, 1
    s_cbranch_scc1 K1_KG_T1
    v_lshrrev_b32 v40, 2, v32
    v_and_b32 v36, 3, v32
    v_lshlrev_b32 v36, 1, v36
    v_lshl_add_u32 v36, v40, 7, v36
    v_add_u32 v36, 256, v36
    v_lshrrev_b32 v40, 1, v32
    v_lshlrev_b32 v40, 7, v40
    v_and_b32 v41, 1, v32
    v_lshl_add_u32 v40, v41, 2, v40
    v_cmp_gt_u32 vcc, 8, v32
    s_nop 1
    v_cndmask_b32 v36, v40, v36, vcc
    v_lshrrev_b32 v40, 2, v33
    v_and_b32 v37, 3, v33
    v_lshlrev_b32 v37, 1, v37
    v_lshl_add_u32 v37, v40, 7, v37
    v_add_u32 v37, 256, v37
    v_lshrrev_b32 v40, 1, v33
    v_lshlrev_b32 v40, 7, v40
    v_and_b32 v41, 1, v33
    v_lshl_add_u32 v40, v41, 2, v40
    v_cmp_gt_u32 vcc, 8, v33
    s_nop 1
    v_cndmask_b32 v37, v40, v37, vcc
    v_lshrrev_b32 v40, 2, v34
    v_and_b32 v38, 3, v34
    v_lshlrev_b32 v38, 1, v38
    v_lshl_add_u32 v38, v40, 7, v38
    v_add_u32 v38, 256, v38
    v_lshrrev_b32 v40, 1, v34
    v_lshlrev_b32 v40, 7, v40
    v_and_b32 v41, 1, v34
    v_lshl_add_u32 v40, v41, 2, v40
    v_cmp_gt_u32 vcc, 8, v34
    s_nop 1
    v_cndmask_b32 v38, v40, v38, vcc
    v_lshrrev_b32 v40, 2, v35
    v_and_b32 v39, 3, v35
    v_lshlrev_b32 v39, 1, v39
    v_lshl_add_u32 v39, v40, 7, v39
    v_add_u32 v39, 256, v39
    v_lshrrev_b32 v40, 1, v35
    v_lshlrev_b32 v40, 7, v40
    v_and_b32 v41, 1, v35
    v_lshl_add_u32 v40, v41, 2, v40
    v_cmp_gt_u32 vcc, 8, v35
    s_nop 1
    v_cndmask_b32 v39, v40, v39, vcc
K1_KG_T1:
    s_cmp_lg_u32 s45, 2
    s_cbranch_scc1 K1_KG_T2
    v_lshlrev_b32 v36, 7, v32
    v_add_u32 v36, 1024, v36
    v_lshlrev_b32 v37, 7, v33
    v_add_u32 v37, 1024, v37
    v_lshlrev_b32 v38, 7, v34
    v_add_u32 v38, 1024, v38
    v_lshlrev_b32 v39, 7, v35
    v_add_u32 v39, 1024, v39
K1_KG_T2:
    s_waitcnt lgkmcnt(0)
    s_barrier
    s_cmp_ge_u32 s45, 3
    s_cbranch_scc1 K1_KG_SKIP
    v_lshlrev_b32 v5, 4, v0
    ds_read_b128 v[8:11], v5 offset:0
    ds_read_b128 v[12:15], v5 offset:3072
    ds_read_b128 v[16:19], v5 offset:6144
    ds_read_b128 v[20:23], v5 offset:9216
    v_lshl_add_u32 v36, v4, 3, v36
    v_lshlrev_b32 v36, 1, v36
    v_lshl_add_u32 v37, v4, 3, v37
    v_lshlrev_b32 v37, 1, v37
    v_lshl_add_u32 v38, v4, 3, v38
    v_lshlrev_b32 v38, 1, v38
    v_lshl_add_u32 v39, v4, 3, v39
    v_lshlrev_b32 v39, 1, v39
    s_waitcnt lgkmcnt(0)
    v_pk_add_f32 v[8:9], v[8:9], v[12:13]
    v_pk_add_f32 v[10:11], v[10:11], v[14:15]
    v_pk_add_f32 v[16:17], v[16:17], v[20:21]
    v_pk_add_f32 v[18:19], v[18:19], v[22:23]
    v_pk_add_f32 v[8:9], v[8:9], v[16:17]
    v_pk_add_f32 v[10:11], v[10:11], v[18:19]
    v_cvt_pk_bf16_f32 v8, v8, v9
    v_cvt_pk_bf16_f32 v10, v10, v11
    ds_write_b16 v36, v8 offset:12288
    ds_write_b16_d16_hi v37, v8 offset:12288
    ds_write_b16 v38, v10 offset:12288
    ds_write_b16_d16_hi v39, v10 offset:12288
K1_KG_SKIP:
    s_waitcnt lgkmcnt(0)
    s_barrier
    ds_read_u16 v24, v114 offset:12288
    ds_read_u16 v25, v115 offset:12288
    ds_read_u16 v26, v116 offset:12288
    ds_read_u16 v27, v117 offset:12288
    ds_read_u16 v28, v118 offset:12288
    ds_read_u16 v29, v119 offset:12288
    ds_read_u16 v30, v120 offset:12288
    ds_read_u16 v31, v121 offset:12288
    v_lshlrev_b32 v5, 4, v0
    s_mul_i32 s44, s23, 4160
    v_mov_b32 v40, 0
    v_mov_b32 v41, 0
    v_mov_b32 v42, 0
    v_mov_b32 v43, 0
    s_waitcnt lgkmcnt(0)
    v_lshl_or_b32 v16, v25, 16, v24
    v_lshl_or_b32 v17, v27, 16, v26
    v_lshl_or_b32 v18, v29, 16, v28
    v_lshl_or_b32 v19, v31, 16, v30
    buffer_store_dwordx4 v[16:19], v5, s[40:43], s44 offen offset:32
    v_cmp_gt_u32 vcc, 2, v0
    s_nop 0
    s_and_saveexec_b64 s[56:57], vcc
    s_cbranch_execz K1_KG_END
    buffer_store_dwordx4 v[40:43], v5, s[40:43], s44 offen
K1_KG_END:
    s_endpgm
K1_W2:
    s_and_b32 s24, s3, 7
    s_mul_i32 s24, s24, 18
    s_lshr_b32 s3, s3, 3
    s_add_u32 s3, s3, s24
    s_load_dwordx2 s[6:7], s[0:1], 72
    s_mov_b32 s23, s3
    s_lshl_b32 s20, s23, 5
    s_waitcnt lgkmcnt(0)
    s_mov_b32 s8, s6
    s_mov_b32 s9, s7
    s_mov_b32 s10, 0x510000
    s_mov_b32 s11, 0x00020000
    s_add_u32 s12, s4, 0x1800000
    s_addc_u32 s13, s5, 0
    s_mov_b32 s14, 0x510000
    s_mov_b32 s15, 0x00020000
    v_lshrrev_b32 v1, 3, v0
    v_and_b32 v2, 7, v0
    v_add_u32 v3, s20, v1
    v_mul_u32_u24 v3, 1152, v3
    v_lshl_add_u32 v3, v2, 4, v3
    buffer_load_dwordx4 v[8:11], v3, s[8:11], 0 offen offset:0 nt
    buffer_load_dwordx4 v[12:15], v3, s[8:11], 0 offen offset:128 nt
    buffer_load_dwordx4 v[16:19], v3, s[8:11], 0 offen offset:256 nt
    buffer_load_dwordx4 v[20:23], v3, s[8:11], 0 offen offset:384 nt
    buffer_load_dwordx4 v[24:27], v3, s[8:11], 0 offen offset:512 nt
    buffer_load_dwordx4 v[28:31], v3, s[8:11], 0 offen offset:640 nt
    buffer_load_dwordx4 v[32:35], v3, s[8:11], 0 offen offset:768 nt
    buffer_load_dwordx4 v[36:39], v3, s[8:11], 0 offen offset:896 nt
    buffer_load_dwordx4 v[40:43], v3, s[8:11], 0 offen offset:1024 nt
    v_mul_u32_u24 v4, 1184, v1
    v_lshl_add_u32 v4, v2, 4, v4
    v_and_b32 v116, 63, v0
    v_lshrrev_b32 v117, 6, v0
    v_lshrrev_b32 v120, 2, v116
    v_mul_u32_u24 v5, 1184, v120
    v_and_b32 v120, 3, v116
    v_lshl_add_u32 v5, v120, 3, v5
    v_mul_u32_u24 v120, 288, v117
    v_add_u32 v5, v5, v120
    s_mul_i32 s24, s23, 57
    s_lshr_b32 s24, s24, 10
    s_mul_i32 s25, s24, 18
    s_sub_u32 s25, s23, s25
    s_mul_i32 s24, s24, 663552
    s_mul_i32 s25, s25, 3072
    s_add_u32 s24, s24, s25
    v_mul_u32_u24 v6, 165888, v117
    v_lshl_add_u32 v6, v116, 4, v6
    v_add_u32 v6, s24, v6
    s_waitcnt vmcnt(0)
    ds_write_b128 v4, v[8:11] offset:0
    ds_write_b128 v4, v[12:15] offset:128
    ds_write_b128 v4, v[16:19] offset:256
    ds_write_b128 v4, v[20:23] offset:384
    ds_write_b128 v4, v[24:27] offset:512
    ds_write_b128 v4, v[28:31] offset:640
    ds_write_b128 v4, v[32:35] offset:768
    ds_write_b128 v4, v[36:39] offset:896
    ds_write_b128 v4, v[40:43] offset:1024
    s_waitcnt lgkmcnt(0)
    s_barrier
    ds_read_b64_tr_b16 v[8:9], v5 offset:0
    ds_read_b64_tr_b16 v[10:11], v5 offset:18944
    ds_read_b64_tr_b16 v[12:13], v5 offset:32
    ds_read_b64_tr_b16 v[14:15], v5 offset:18976
    ds_read_b64_tr_b16 v[16:17], v5 offset:64
    ds_read_b64_tr_b16 v[18:19], v5 offset:19008
    ds_read_b64_tr_b16 v[20:21], v5 offset:96
    ds_read_b64_tr_b16 v[22:23], v5 offset:19040
    ds_read_b64_tr_b16 v[24:25], v5 offset:128
    ds_read_b64_tr_b16 v[26:27], v5 offset:19072
    ds_read_b64_tr_b16 v[28:29], v5 offset:160
    ds_read_b64_tr_b16 v[30:31], v5 offset:19104
    ds_read_b64_tr_b16 v[32:33], v5 offset:192
    ds_read_b64_tr_b16 v[34:35], v5 offset:19136
    ds_read_b64_tr_b16 v[36:37], v5 offset:224
    ds_read_b64_tr_b16 v[38:39], v5 offset:19168
    ds_read_b64_tr_b16 v[40:41], v5 offset:256
    ds_read_b64_tr_b16 v[42:43], v5 offset:19200
    s_waitcnt lgkmcnt(0)
    s_mov_b32 s22, 0
    buffer_store_dwordx4 v[8:11], v6, s[12:15], s22 offen sc1
    s_mov_b32 s22, 1024
    buffer_store_dwordx4 v[12:15], v6, s[12:15], s22 offen sc1
    s_mov_b32 s22, 2048
    buffer_store_dwordx4 v[16:19], v6, s[12:15], s22 offen sc1
    s_mov_b32 s22, 55296
    buffer_store_dwordx4 v[20:23], v6, s[12:15], s22 offen sc1
    s_mov_b32 s22, 56320
    buffer_store_dwordx4 v[24:27], v6, s[12:15], s22 offen sc1
    s_mov_b32 s22, 57344
    buffer_store_dwordx4 v[28:31], v6, s[12:15], s22 offen sc1
    s_mov_b32 s22, 110592
    buffer_store_dwordx4 v[32:35], v6, s[12:15], s22 offen sc1
    s_mov_b32 s22, 111616
    buffer_store_dwordx4 v[36:39], v6, s[12:15], s22 offen sc1
    s_mov_b32 s22, 112640
    buffer_store_dwordx4 v[40:43], v6, s[12:15], s22 offen sc1
    s_endpgm

.globl k2_kernel
.p2align 8
.type k2_kernel,@function
k2_kernel:
    s_load_dwordx2 s[4:5], s[0:1], 112
    s_mov_b32 s3, s2
    s_cmp_lt_u32 s3, 576
    s_cbranch_scc1 K2_CV
    s_sub_u32 s3, s3, 576
    s_cmp_lt_u32 s3, 144
    s_cbranch_scc1 K2_W1
    s_endpgm
K2_CV:
    s_load_dwordx2 s[6:7], s[0:1], 48
    s_mov_b32 s23, s3
    s_lshl_b32 s22, s23, 1
    s_and_b32 s22, s22, 0xfffffffc
    s_lshl_b32 s24, s23, 2
    s_add_u32 s25, s24, 2304
    s_add_u32 s26, s24, 4608
    s_add_u32 s27, s24, 9216
    s_lshl_b32 s44, s23, 12
    s_mul_i32 s45, s23, 4160
    v_lshlrev_b32 v1, 4, v0
    v_lshlrev_b32 v2, 5, v0
    v_and_b32 v20, 15, v0
    v_bfe_u32 v21, v0, 4, 2
    v_lshrrev_b32 v22, 6, v0
    s_waitcnt lgkmcnt(0)
    s_load_dword s34, s[6:7], s22
    s_load_dword s35, s[4:5], s24
    s_load_dword s36, s[4:5], s25
    s_load_dword s37, s[4:5], s26
    s_load_dword s33, s[4:5], s27
    s_add_u32 s16, s4, 0x700000
    s_addc_u32 s17, s5, 0
    s_mov_b32 s18, 0x249000
    s_mov_b32 s19, 0x00020000
    buffer_load_dwordx4 v[72:75], v1, s[16:19], s45 offen offset:16
    buffer_load_dwordx4 v[76:79], v1, s[16:19], s45 offen offset:32
    buffer_load_dwordx4 v[80:83], v1, s[16:19], s45 offen offset:20
    buffer_load_dwordx4 v[84:87], v1, s[16:19], s45 offen offset:36
    s_add_u32 s8, s4, 0x100000
    s_addc_u32 s9, s5, 0
    s_mov_b32 s10, 0x240000
    s_mov_b32 s11, 0x00020000
    buffer_load_dwordx4 v[12:15], v1, s[8:11], s44 offen
    s_add_u32 s12, s4, 0x30000
    s_addc_u32 s13, s5, 0
    s_mov_b32 s14, 0x2000
    s_mov_b32 s15, 0x00020000
    buffer_load_dwordx4 v[40:43], v2, s[12:15], 0 offen
    buffer_load_dwordx4 v[44:47], v2, s[12:15], 0 offen offset:16
    s_add_u32 s40, s4, 0xc00000
    s_addc_u32 s41, s5, 0
    s_mov_b32 s42, 0x240000
    s_mov_b32 s43, 0x00020000
    v_mov_b32 v16, 0
    v_mov_b32 v17, 0
    v_mov_b32 v18, 0
    v_mov_b32 v19, 0
    v_add_u32 v3, 4096, v1
    v_add_u32 v23, 4096, v1
    v_cmp_gt_u32 vcc, 32, v0
    s_nop 1
    v_cndmask_b32 v3, v23, v3, vcc
    v_cmp_gt_u32 vcc, 40, v0
    s_nop 0
    s_and_saveexec_b64 s[46:47], vcc
    ds_write_b128 v3, v[16:19]
    s_mov_b64 exec, s[46:47]
    v_lshlrev_b32 v23, 7, v22
    v_lshl_add_u32 v23, v21, 4, v23
    v_lshlrev_b32 v25, 5, v20
    v_sub_u32 v23, v23, v25
    v_add_u32 v23, 480, v23
    v_sub_u32 v25, 4080, v1
    v_lshl_add_u32 v24, v21, 3, v20
    v_lshl_add_u32 v24, v22, 6, v24
    v_add_u32 v24, 1, v24
    v_bfe_u32 v30, v24, 3, 3
    v_xor_b32 v30, v24, v30
    v_lshlrev_b32 v30, 4, v30
    v_mov_b32 v29, v30
    v_add_u32 v24, 32, v24
    v_bfe_u32 v30, v24, 3, 3
    v_xor_b32 v31, v24, v30
    v_lshlrev_b32 v31, 4, v31
    v_mov_b32 v30, v29
    v_add_u32 v26, 1, v0
    v_and_b32 v27, 7, v26
    v_lshlrev_b32 v27, 4, v27
    v_lshlrev_b32 v26, 7, v26
    v_xor_b32 v104, 0, v27
    v_add_u32 v104, v26, v104
    v_xor_b32 v105, 16, v27
    v_add_u32 v105, v26, v105
    v_xor_b32 v106, 32, v27
    v_add_u32 v106, v26, v106
    v_xor_b32 v107, 48, v27
    v_add_u32 v107, v26, v107
    v_xor_b32 v108, 64, v27
    v_add_u32 v108, v26, v108
    v_xor_b32 v109, 80, v27
    v_add_u32 v109, v26, v109
    v_xor_b32 v110, 96, v27
    v_add_u32 v110, v26, v110
    v_xor_b32 v111, 112, v27
    v_add_u32 v111, v26, v111
    s_waitcnt vmcnt(3)
    v_alignbit_b32 v88, v73, v72, 16
    v_alignbit_b32 v96, v81, v80, 16
    v_alignbit_b32 v89, v74, v73, 16
    v_alignbit_b32 v97, v82, v81, 16
    v_alignbit_b32 v90, v75, v74, 16
    v_alignbit_b32 v98, v83, v82, 16
    v_alignbit_b32 v91, v76, v75, 16
    v_alignbit_b32 v99, v84, v83, 16
    v_alignbit_b32 v92, v77, v76, 16
    v_alignbit_b32 v100, v85, v84, 16
    v_alignbit_b32 v93, v78, v77, 16
    v_alignbit_b32 v101, v86, v85, 16
    ds_write_b128 v104, v[72:75] offset:4608
    ds_write_b128 v105, v[88:91] offset:4608
    ds_write_b128 v106, v[80:83] offset:4608
    ds_write_b128 v107, v[96:99] offset:4608
    ds_write_b128 v108, v[74:77] offset:4608
    ds_write_b128 v109, v[90:93] offset:4608
    ds_write_b128 v110, v[82:85] offset:4608
    ds_write_b128 v111, v[98:101] offset:4608
    v_cmp_eq_u32 vcc, 255, v0
    v_mov_b32 v3, 0
    s_and_saveexec_b64 s[46:47], vcc
    ds_write_b128 v3, v[76:79] offset:37520
    s_mov_b64 exec, s[46:47]
    s_waitcnt lgkmcnt(0)
    s_and_b32 s22, s23, 1
    s_lshl_b32 s22, s22, 4
    s_lshr_b32 s34, s34, s22
    s_lshl_b32 s34, s34, 16
    s_mov_b32 s38, s35
    s_mov_b32 s39, s35
    v_add_f32 v26, 1.0, s36
    v_cvt_pk_bf16_f32 v26, v26, v26
    v_lshlrev_b32 v26, 16, v26
    s_waitcnt vmcnt(0)
    v_lshlrev_b32 v48, 16, v12
    v_and_b32 v49, 0xffff0000, v12
    v_lshlrev_b32 v50, 16, v13
    v_and_b32 v51, 0xffff0000, v13
    v_lshlrev_b32 v52, 16, v14
    v_and_b32 v53, 0xffff0000, v14
    v_lshlrev_b32 v54, 16, v15
    v_and_b32 v55, 0xffff0000, v15
    v_lshlrev_b32 v56, 16, v40
    v_and_b32 v64, 0xffff0000, v40
    v_lshlrev_b32 v57, 16, v41
    v_and_b32 v65, 0xffff0000, v41
    v_lshlrev_b32 v58, 16, v42
    v_and_b32 v66, 0xffff0000, v42
    v_lshlrev_b32 v59, 16, v43
    v_and_b32 v67, 0xffff0000, v43
    v_lshlrev_b32 v60, 16, v44
    v_and_b32 v68, 0xffff0000, v44
    v_lshlrev_b32 v61, 16, v45
    v_and_b32 v69, 0xffff0000, v45
    v_lshlrev_b32 v62, 16, v46
    v_and_b32 v70, 0xffff0000, v46
    v_lshlrev_b32 v63, 16, v47
    v_and_b32 v71, 0xffff0000, v47
    v_rcp_f32 v64, v64
    v_rcp_f32 v65, v65
    v_rcp_f32 v66, v66
    v_rcp_f32 v67, v67
    v_rcp_f32 v68, v68
    v_rcp_f32 v69, v69
    v_rcp_f32 v70, v70
    v_rcp_f32 v71, v71
    v_pk_add_f32 v[32:33], v[48:49], v[56:57] neg_lo:[0,1] neg_hi:[0,1]
    v_pk_add_f32 v[34:35], v[50:51], v[58:59] neg_lo:[0,1] neg_hi:[0,1]
    v_pk_add_f32 v[36:37], v[52:53], v[60:61] neg_lo:[0,1] neg_hi:[0,1]
    v_pk_add_f32 v[38:39], v[54:55], v[62:63] neg_lo:[0,1] neg_hi:[0,1]
    v_cvt_pk_bf16_f32 v4, v32, v33
    v_cvt_pk_bf16_f32 v5, v34, v35
    v_cvt_pk_bf16_f32 v6, v36, v37
    v_cvt_pk_bf16_f32 v7, v38, v39
    v_lshlrev_b32 v32, 16, v4
    v_and_b32 v33, 0xffff0000, v4
    v_lshlrev_b32 v34, 16, v5
    v_and_b32 v35, 0xffff0000, v5
    v_lshlrev_b32 v36, 16, v6
    v_and_b32 v37, 0xffff0000, v6
    v_lshlrev_b32 v38, 16, v7
    v_and_b32 v39, 0xffff0000, v7
    v_pk_mul_f32 v[32:33], v[32:33], v[64:65]
    v_pk_mul_f32 v[34:35], v[34:35], v[66:67]
    v_pk_mul_f32 v[36:37], v[36:37], v[68:69]
    v_pk_mul_f32 v[38:39], v[38:39], v[70:71]
    v_cvt_pk_bf16_f32 v4, v32, v33
    v_cvt_pk_bf16_f32 v5, v34, v35
    v_cvt_pk_bf16_f32 v6, v36, v37
    v_cvt_pk_bf16_f32 v7, v38, v39
    v_lshlrev_b32 v32, 16, v4
    v_and_b32 v33, 0xffff0000, v4
    v_lshlrev_b32 v34, 16, v5
    v_and_b32 v35, 0xffff0000, v5
    v_lshlrev_b32 v36, 16, v6
    v_and_b32 v37, 0xffff0000, v6
    v_lshlrev_b32 v38, 16, v7
    v_and_b32 v39, 0xffff0000, v7
    v_pk_mul_f32 v[32:33], v[32:33], v[26:27] op_sel_hi:[1,0]
    v_pk_mul_f32 v[34:35], v[34:35], v[26:27] op_sel_hi:[1,0]
    v_pk_mul_f32 v[36:37], v[36:37], v[26:27] op_sel_hi:[1,0]
    v_pk_mul_f32 v[38:39], v[38:39], v[26:27] op_sel_hi:[1,0]
    v_cvt_pk_bf16_f32 v4, v32, v33
    v_cvt_pk_bf16_f32 v5, v34, v35
    v_cvt_pk_bf16_f32 v6, v36, v37
    v_cvt_pk_bf16_f32 v7, v38, v39
    v_lshlrev_b32 v32, 16, v4
    v_and_b32 v33, 0xffff0000, v4
    v_lshlrev_b32 v34, 16, v5
    v_and_b32 v35, 0xffff0000, v5
    v_lshlrev_b32 v36, 16, v6
    v_and_b32 v37, 0xffff0000, v6
    v_lshlrev_b32 v38, 16, v7
    v_and_b32 v39, 0xffff0000, v7
    v_pk_add_f32 v[32:33], v[32:33], s[38:39]
    v_pk_add_f32 v[34:35], v[34:35], s[38:39]
    v_pk_add_f32 v[36:37], v[36:37], s[38:39]
    v_pk_add_f32 v[38:39], v[38:39], s[38:39]
    v_cvt_pk_bf16_f32 v4, v39, v38
    v_cvt_pk_bf16_f32 v5, v37, v36
    v_cvt_pk_bf16_f32 v6, v35, v34
    v_cvt_pk_bf16_f32 v7, v33, v32
    ds_write_b128 v25, v[4:7]
    v_lshlrev_b32 v39, 16, v4
    v_and_b32 v38, 0xffff0000, v4
    v_lshlrev_b32 v37, 16, v5
    v_and_b32 v36, 0xffff0000, v5
    v_lshlrev_b32 v35, 16, v6
    v_and_b32 v34, 0xffff0000, v6
    v_lshlrev_b32 v33, 16, v7
    v_and_b32 v32, 0xffff0000, v7
    v_mul_f32 v32, s34, v32
    v_mul_f32 v33, s34, v33
    v_mul_f32 v34, s34, v34
    v_mul_f32 v35, s34, v35
    v_mul_f32 v36, s34, v36
    v_mul_f32 v37, s34, v37
    v_mul_f32 v38, s34, v38
    v_mul_f32 v39, s34, v39
    v_and_b32 v27, 63, v0
    v_lshlrev_b32 v27, 4, v27
    v_lshl_add_u32 v27, v22, 13, v27
    v_lshrrev_b32 v28, 5, v0
    v_lshlrev_b32 v28, 10, v28
    v_bfe_u32 v29, v0, 1, 4
    v_lshl_add_u32 v28, v29, 4, v28
    v_and_b32 v29, 1, v0
    v_lshl_add_u32 v28, v29, 9, v28
    s_waitcnt lgkmcnt(0)
    s_barrier
    ds_read_b128 v[64:67], v23 offset:3584
    ds_read_b128 v[96:99], v30 offset:4608
    ds_read_b128 v[68:71], v23 offset:3072
    ds_read_b128 v[100:103], v30 offset:8704
    ds_read_b128 v[72:75], v23 offset:2560
    ds_read_b128 v[104:107], v30 offset:12800
    ds_read_b128 v[76:79], v23 offset:2048
    ds_read_b128 v[108:111], v30 offset:16896
    ds_read_b128 v[80:83], v23 offset:1536
    ds_read_b128 v[112:115], v30 offset:20992
    ds_read_b128 v[84:87], v23 offset:1024
    ds_read_b128 v[116:119], v30 offset:25088
    ds_read_b128 v[88:91], v23 offset:512
    ds_read_b128 v[120:123], v30 offset:29184
    ds_read_b128 v[92:95], v23 offset:0
    ds_read_b128 v[124:127], v30 offset:33280
    v_cvt_pk_bf16_f32 v8, v32, v33
    v_cvt_pk_bf16_f32 v9, v34, v35
    v_cvt_pk_bf16_f32 v10, v36, v37
    v_cvt_pk_bf16_f32 v11, v38, v39
    s_waitcnt lgkmcnt(14)
    v_mfma_f32_16x16x32_bf16 v[32:35], v[96:99], v[64:67], 0
    s_waitcnt lgkmcnt(12)
    v_mfma_f32_16x16x32_bf16 v[36:39], v[96:99], v[68:71], 0
    v_mfma_f32_16x16x32_bf16 v[36:39], v[100:103], v[64:67], v[36:39]
    v_mfma_f32_16x16x32_bf16 v[40:43], v[100:103], v[68:71], 0
    s_waitcnt lgkmcnt(10)
    v_mfma_f32_16x16x32_bf16 v[40:43], v[96:99], v[72:75], v[40:43]
    v_mfma_f32_16x16x32_bf16 v[44:47], v[100:103], v[72:75], 0
    v_mfma_f32_16x16x32_bf16 v[40:43], v[104:107], v[64:67], v[40:43]
    v_mfma_f32_16x16x32_bf16 v[44:47], v[104:107], v[68:71], v[44:47]
    v_mfma_f32_16x16x32_bf16 v[48:51], v[104:107], v[72:75], 0
    s_waitcnt lgkmcnt(8)
    v_mfma_f32_16x16x32_bf16 v[44:47], v[96:99], v[76:79], v[44:47]
    v_mfma_f32_16x16x32_bf16 v[48:51], v[100:103], v[76:79], v[48:51]
    v_mfma_f32_16x16x32_bf16 v[52:55], v[104:107], v[76:79], 0
    v_mfma_f32_16x16x32_bf16 v[44:47], v[108:111], v[64:67], v[44:47]
    v_mfma_f32_16x16x32_bf16 v[48:51], v[108:111], v[68:71], v[48:51]
    v_mfma_f32_16x16x32_bf16 v[52:55], v[108:111], v[72:75], v[52:55]
    v_mfma_f32_16x16x32_bf16 v[56:59], v[108:111], v[76:79], 0
    s_waitcnt lgkmcnt(6)
    v_mfma_f32_16x16x32_bf16 v[48:51], v[96:99], v[80:83], v[48:51]
    v_mfma_f32_16x16x32_bf16 v[52:55], v[100:103], v[80:83], v[52:55]
    v_mfma_f32_16x16x32_bf16 v[56:59], v[104:107], v[80:83], v[56:59]
    v_mfma_f32_16x16x32_bf16 v[60:63], v[108:111], v[80:83], 0
    v_mfma_f32_16x16x32_bf16 v[48:51], v[112:115], v[64:67], v[48:51]
    v_mfma_f32_16x16x32_bf16 v[52:55], v[112:115], v[68:71], v[52:55]
    v_mfma_f32_16x16x32_bf16 v[56:59], v[112:115], v[72:75], v[56:59]
    v_mfma_f32_16x16x32_bf16 v[60:63], v[112:115], v[76:79], v[60:63]
    s_waitcnt lgkmcnt(4)
    v_mfma_f32_16x16x32_bf16 v[52:55], v[96:99], v[84:87], v[52:55]
    v_mfma_f32_16x16x32_bf16 v[56:59], v[100:103], v[84:87], v[56:59]
    v_mfma_f32_16x16x32_bf16 v[60:63], v[104:107], v[84:87], v[60:63]
    v_mfma_f32_16x16x32_bf16 v[52:55], v[116:119], v[64:67], v[52:55]
    v_mfma_f32_16x16x32_bf16 v[56:59], v[116:119], v[68:71], v[56:59]
    v_mfma_f32_16x16x32_bf16 v[60:63], v[116:119], v[72:75], v[60:63]
    s_waitcnt lgkmcnt(2)
    v_mfma_f32_16x16x32_bf16 v[56:59], v[96:99], v[88:91], v[56:59]
    v_mfma_f32_16x16x32_bf16 v[60:63], v[100:103], v[88:91], v[60:63]
    v_mfma_f32_16x16x32_bf16 v[56:59], v[120:123], v[64:67], v[56:59]
    v_mfma_f32_16x16x32_bf16 v[60:63], v[120:123], v[68:71], v[60:63]
    s_waitcnt lgkmcnt(0)
    v_mfma_f32_16x16x32_bf16 v[60:63], v[96:99], v[92:95], v[60:63]
    v_mfma_f32_16x16x32_bf16 v[60:63], v[124:127], v[64:67], v[60:63]
    ds_read_b128 v[64:67], v23 offset:3648
    ds_read_b128 v[96:99], v31 offset:4608
    ds_read_b128 v[68:71], v23 offset:3136
    ds_read_b128 v[100:103], v31 offset:8704
    ds_read_b128 v[72:75], v23 offset:2624
    ds_read_b128 v[104:107], v31 offset:12800
    ds_read_b128 v[76:79], v23 offset:2112
    ds_read_b128 v[108:111], v31 offset:16896
    ds_read_b128 v[80:83], v23 offset:1600
    ds_read_b128 v[112:115], v31 offset:20992
    ds_read_b128 v[84:87], v23 offset:1088
    ds_read_b128 v[116:119], v31 offset:25088
    ds_read_b128 v[88:91], v23 offset:576
    ds_read_b128 v[120:123], v31 offset:29184
    ds_read_b128 v[92:95], v23 offset:64
    ds_read_b128 v[124:127], v31 offset:33280
    s_waitcnt lgkmcnt(14)
    v_mfma_f32_16x16x32_bf16 v[32:35], v[96:99], v[64:67], v[32:35]
    s_waitcnt lgkmcnt(12)
    v_mfma_f32_16x16x32_bf16 v[36:39], v[96:99], v[68:71], v[36:39]
    v_mfma_f32_16x16x32_bf16 v[36:39], v[100:103], v[64:67], v[36:39]
    v_mfma_f32_16x16x32_bf16 v[40:43], v[100:103], v[68:71], v[40:43]
    s_waitcnt lgkmcnt(10)
    v_mfma_f32_16x16x32_bf16 v[40:43], v[96:99], v[72:75], v[40:43]
    v_mfma_f32_16x16x32_bf16 v[44:47], v[100:103], v[72:75], v[44:47]
    v_mfma_f32_16x16x32_bf16 v[40:43], v[104:107], v[64:67], v[40:43]
    v_mfma_f32_16x16x32_bf16 v[44:47], v[104:107], v[68:71], v[44:47]
    v_mfma_f32_16x16x32_bf16 v[48:51], v[104:107], v[72:75], v[48:51]
    s_waitcnt lgkmcnt(8)
    v_mfma_f32_16x16x32_bf16 v[44:47], v[96:99], v[76:79], v[44:47]
    v_mfma_f32_16x16x32_bf16 v[48:51], v[100:103], v[76:79], v[48:51]
    v_mfma_f32_16x16x32_bf16 v[52:55], v[104:107], v[76:79], v[52:55]
    v_mfma_f32_16x16x32_bf16 v[44:47], v[108:111], v[64:67], v[44:47]
    v_mfma_f32_16x16x32_bf16 v[48:51], v[108:111], v[68:71], v[48:51]
    v_mfma_f32_16x16x32_bf16 v[52:55], v[108:111], v[72:75], v[52:55]
    v_mfma_f32_16x16x32_bf16 v[56:59], v[108:111], v[76:79], v[56:59]
    s_waitcnt lgkmcnt(6)
    v_mfma_f32_16x16x32_bf16 v[48:51], v[96:99], v[80:83], v[48:51]
    v_mfma_f32_16x16x32_bf16 v[52:55], v[100:103], v[80:83], v[52:55]
    v_mfma_f32_16x16x32_bf16 v[56:59], v[104:107], v[80:83], v[56:59]
    v_mfma_f32_16x16x32_bf16 v[60:63], v[108:111], v[80:83], v[60:63]
    v_mfma_f32_16x16x32_bf16 v[48:51], v[112:115], v[64:67], v[48:51]
    v_mfma_f32_16x16x32_bf16 v[52:55], v[112:115], v[68:71], v[52:55]
    v_mfma_f32_16x16x32_bf16 v[56:59], v[112:115], v[72:75], v[56:59]
    v_mfma_f32_16x16x32_bf16 v[60:63], v[112:115], v[76:79], v[60:63]
    s_waitcnt lgkmcnt(4)
    v_mfma_f32_16x16x32_bf16 v[52:55], v[96:99], v[84:87], v[52:55]
    v_mfma_f32_16x16x32_bf16 v[56:59], v[100:103], v[84:87], v[56:59]
    v_mfma_f32_16x16x32_bf16 v[60:63], v[104:107], v[84:87], v[60:63]
    v_mfma_f32_16x16x32_bf16 v[52:55], v[116:119], v[64:67], v[52:55]
    v_mfma_f32_16x16x32_bf16 v[56:59], v[116:119], v[68:71], v[56:59]
    v_mfma_f32_16x16x32_bf16 v[60:63], v[116:119], v[72:75], v[60:63]
    s_waitcnt lgkmcnt(2)
    v_mfma_f32_16x16x32_bf16 v[56:59], v[96:99], v[88:91], v[56:59]
    v_mfma_f32_16x16x32_bf16 v[60:63], v[100:103], v[88:91], v[60:63]
    v_mfma_f32_16x16x32_bf16 v[56:59], v[120:123], v[64:67], v[56:59]
    v_mfma_f32_16x16x32_bf16 v[60:63], v[120:123], v[68:71], v[60:63]
    s_waitcnt lgkmcnt(0)
    s_barrier
    v_mfma_f32_16x16x32_bf16 v[60:63], v[96:99], v[92:95], v[60:63]
    v_mfma_f32_16x16x32_bf16 v[60:63], v[124:127], v[64:67], v[60:63]
    ds_write_b128 v27, v[32:35] offset:4608
    ds_write_b128 v27, v[36:39] offset:5632
    ds_write_b128 v27, v[40:43] offset:6656
    ds_write_b128 v27, v[44:47] offset:7680
    ds_write_b128 v27, v[48:51] offset:8704
    ds_write_b128 v27, v[52:55] offset:9728
    ds_write_b128 v27, v[56:59] offset:10752
    s_nop 0
    ds_write_b128 v27, v[60:63] offset:11776
    v_lshrrev_b32 v2, 3, v0
    v_mul_u32_u24 v2, 73728, v2
    v_and_b32 v3, 7, v0
    v_lshl_add_u32 v2, v3, 4, v2
    s_lshl_b32 s44, s23, 7
    s_mov_b32 s38, s37
    s_mov_b32 s39, s37
    s_waitcnt lgkmcnt(0)
    s_barrier
    ds_read_b128 v[64:67], v28 offset:4608
    ds_read_b128 v[68:71], v28 offset:4864
    ds_read_b128 v[72:75], v28 offset:12800
    ds_read_b128 v[76:79], v28 offset:13056
    ds_read_b128 v[80:83], v28 offset:20992
    ds_read_b128 v[84:87], v28 offset:21248
    ds_read_b128 v[88:91], v28 offset:29184
    ds_read_b128 v[92:95], v28 offset:29440
    v_lshlrev_b32 v32, 16, v8
    v_and_b32 v33, 0xffff0000, v8
    v_lshlrev_b32 v34, 16, v9
    v_and_b32 v35, 0xffff0000, v9
    v_lshlrev_b32 v36, 16, v10
    v_and_b32 v37, 0xffff0000, v10
    v_lshlrev_b32 v38, 16, v11
    v_and_b32 v39, 0xffff0000, v11
    v_lshlrev_b32 v40, 16, v12
    v_and_b32 v41, 0xffff0000, v12
    v_lshlrev_b32 v42, 16, v13
    v_and_b32 v43, 0xffff0000, v13
    v_lshlrev_b32 v44, 16, v14
    v_and_b32 v45, 0xffff0000, v14
    v_lshlrev_b32 v46, 16, v15
    v_and_b32 v47, 0xffff0000, v15
    s_waitcnt lgkmcnt(0)
    v_pk_add_f32 v[64:65], v[64:65], v[72:73]
    v_pk_add_f32 v[80:81], v[80:81], v[88:89]
    v_pk_add_f32 v[66:67], v[66:67], v[74:75]
    v_pk_add_f32 v[82:83], v[82:83], v[90:91]
    v_pk_add_f32 v[68:69], v[68:69], v[76:77]
    v_pk_add_f32 v[84:85], v[84:85], v[92:93]
    v_pk_add_f32 v[70:71], v[70:71], v[78:79]
    v_pk_add_f32 v[86:87], v[86:87], v[94:95]
    v_pk_add_f32 v[64:65], v[64:65], v[80:81]
    v_pk_add_f32 v[66:67], v[66:67], v[82:83]
    v_pk_add_f32 v[68:69], v[68:69], v[84:85]
    v_pk_add_f32 v[70:71], v[70:71], v[86:87]
    v_cvt_pk_bf16_f32 v4, v64, v65
    v_cvt_pk_bf16_f32 v5, v66, v67
    v_cvt_pk_bf16_f32 v6, v68, v69
    v_cvt_pk_bf16_f32 v7, v70, v71
    v_lshlrev_b32 v64, 16, v4
    v_and_b32 v65, 0xffff0000, v4
    v_lshlrev_b32 v66, 16, v5
    v_and_b32 v67, 0xffff0000, v5
    v_lshlrev_b32 v68, 16, v6
    v_and_b32 v69, 0xffff0000, v6
    v_lshlrev_b32 v70, 16, v7
    v_and_b32 v71, 0xffff0000, v7
    v_pk_add_f32 v[64:65], v[64:65], v[32:33]
    v_pk_add_f32 v[66:67], v[66:67], v[34:35]
    v_pk_add_f32 v[68:69], v[68:69], v[36:37]
    v_pk_add_f32 v[70:71], v[70:71], v[38:39]
    v_cvt_pk_bf16_f32 v4, v64, v65
    v_cvt_pk_bf16_f32 v5, v66, v67
    v_cvt_pk_bf16_f32 v6, v68, v69
    v_cvt_pk_bf16_f32 v7, v70, v71
    v_lshlrev_b32 v64, 16, v4
    v_and_b32 v65, 0xffff0000, v4
    v_lshlrev_b32 v66, 16, v5
    v_and_b32 v67, 0xffff0000, v5
    v_lshlrev_b32 v68, 16, v6
    v_and_b32 v69, 0xffff0000, v6
    v_lshlrev_b32 v70, 16, v7
    v_and_b32 v71, 0xffff0000, v7
    v_pk_mul_f32 v[64:65], v[64:65], s[38:39]
    v_pk_mul_f32 v[66:67], v[66:67], s[38:39]
    v_pk_mul_f32 v[68:69], v[68:69], s[38:39]
    v_pk_mul_f32 v[70:71], v[70:71], s[38:39]
    v_cvt_pk_bf16_f32 v4, v64, v65
    v_cvt_pk_bf16_f32 v5, v66, v67
    v_cvt_pk_bf16_f32 v6, v68, v69
    v_cvt_pk_bf16_f32 v7, v70, v71
    v_lshlrev_b32 v64, 16, v4
    v_and_b32 v65, 0xffff0000, v4
    v_lshlrev_b32 v66, 16, v5
    v_and_b32 v67, 0xffff0000, v5
    v_lshlrev_b32 v68, 16, v6
    v_and_b32 v69, 0xffff0000, v6
    v_lshlrev_b32 v70, 16, v7
    v_and_b32 v71, 0xffff0000, v7
    v_pk_add_f32 v[64:65], v[64:65], v[40:41]
    v_pk_add_f32 v[66:67], v[66:67], v[42:43]
    v_pk_add_f32 v[68:69], v[68:69], v[44:45]
    v_pk_add_f32 v[70:71], v[70:71], v[46:47]
    v_cvt_pk_bf16_f32 v4, v64, v65
    v_cvt_pk_bf16_f32 v5, v66, v67
    v_cvt_pk_bf16_f32 v6, v68, v69
    v_cvt_pk_bf16_f32 v7, v70, v71
    buffer_store_dwordx4 v[4:7], v2, s[40:43], s44 offen
    s_endpgm
K2_W1:
    s_and_b32 s24, s3, 7
    s_mul_i32 s24, s24, 18
    s_lshr_b32 s3, s3, 3
    s_add_u32 s3, s3, s24
    s_load_dwordx2 s[6:7], s[0:1], 64
    s_lshl_b32 s23, s3, 6
    v_lshrrev_b32 v2, 2, v0
    v_and_b32 v3, 3, v0
    v_mul_u32_u24 v4, 9216, v2
    v_lshl_add_u32 v4, v3, 4, v4
    v_add_u32 v4, s23, v4
    v_lshlrev_b32 v1, 2, v0
    s_waitcnt lgkmcnt(0)
    s_mov_b32 s8, s6
    s_mov_b32 s9, s7
    s_mov_b32 s10, 0x510000
    s_mov_b32 s11, 0x00020000
    s_mov_b32 s22, 0
    buffer_load_dwordx4 v[8:11], v4, s[8:11], s22 offen nt
    s_mov_b32 s22, 589824
    buffer_load_dwordx4 v[12:15], v4, s[8:11], s22 offen nt
    s_mov_b32 s22, 1179648
    buffer_load_dwordx4 v[16:19], v4, s[8:11], s22 offen nt
    s_mov_b32 s22, 1769472
    buffer_load_dwordx4 v[20:23], v4, s[8:11], s22 offen nt
    s_mov_b32 s22, 2359296
    buffer_load_dwordx4 v[24:27], v4, s[8:11], s22 offen nt
    s_mov_b32 s22, 2949120
    buffer_load_dwordx4 v[28:31], v4, s[8:11], s22 offen nt
    s_mov_b32 s22, 3538944
    buffer_load_dwordx4 v[32:35], v4, s[8:11], s22 offen nt
    s_mov_b32 s22, 4128768
    buffer_load_dwordx4 v[36:39], v4, s[8:11], s22 offen nt
    s_mov_b32 s22, 4718592
    buffer_load_dwordx4 v[40:43], v4, s[8:11], s22 offen nt
    s_mov_b32 s16, s4
    s_mov_b32 s17, s5
    s_mov_b32 s18, 0x3600
    s_mov_b32 s19, 0x00020000
    s_mov_b32 s22, 6912
    buffer_load_dword v100, v1, s[16:19], s22 offen
    s_mov_b32 s22, 9216
    buffer_load_dword v104, v1, s[16:19], s22 offen
    s_mov_b32 s22, 7936
    buffer_load_dword v101, v1, s[16:19], s22 offen
    s_mov_b32 s22, 10240
    buffer_load_dword v105, v1, s[16:19], s22 offen
    s_mov_b32 s22, 8960
    buffer_load_dword v102, v1, s[16:19], s22 offen
    s_mov_b32 s22, 11264
    buffer_load_dword v106, v1, s[16:19], s22 offen
    s_add_u32 s12, s4, 0x1000000
    s_addc_u32 s13, s5, 0
    s_mov_b32 s14, 0x510000
    s_mov_b32 s15, 0x00020000
    s_add_u32 s36, s4, 0x10000
    s_addc_u32 s37, s5, 0
    s_mov_b32 s38, 0x4800
    s_mov_b32 s39, 0x00020000
    s_add_u32 s40, s4, 0x20000
    s_addc_u32 s41, s5, 0
    s_mov_b32 s42, 0x4800
    s_mov_b32 s43, 0x00020000
    v_mul_u32_u24 v5, 64, v2
    v_lshl_add_u32 v5, v3, 4, v5
    v_and_b32 v116, 63, v0
    v_bfe_u32 v117, v0, 6, 1
    v_lshrrev_b32 v111, 7, v0
    v_lshrrev_b32 v118, 2, v116
    v_mul_u32_u24 v6, 64, v118
    v_and_b32 v118, 3, v116
    v_lshl_add_u32 v6, v118, 3, v6
    v_lshl_add_u32 v6, v117, 5, v6
    v_mul_u32_u24 v118, 18432, v111
    v_add_u32 v6, v6, v118
    v_lshrrev_b32 v119, 4, v116
    v_mul_u32_u24 v118, 1152, v111
    v_lshl_add_u32 v7, v119, 4, v118
    v_lshrrev_b32 v108, 1, v7
    s_lshl_b32 s24, s3, 1
    v_readfirstlane_b32 s26, v117
    v_readfirstlane_b32 s28, v111
    s_add_u32 s26, s26, s24
    s_mul_i32 s27, s26, 171
    s_lshr_b32 s27, s27, 9
    s_mul_i32 s29, s27, 3
    s_sub_u32 s26, s26, s29
    s_lshl_b32 s29, s26, 10
    s_mul_i32 s27, s27, 55296
    s_add_u32 s29, s29, s27
    s_mul_i32 s28, s28, 27648
    s_add_u32 s29, s29, s28
    s_mov_b32 s30, 3072
    v_lshlrev_b32 v109, 4, v116
    v_lshlrev_b32 v110, 1, v0
    v_mov_b32 v112, 0x3f803f80
    v_mov_b32 v113, 0x3f803f80
    v_mov_b32 v114, 0x3f803f80
    v_mov_b32 v115, 0x3f803f80
    s_waitcnt vmcnt(14)
    ds_write_b128 v5, v[8:11] offset:0
    s_waitcnt vmcnt(13)
    ds_write_b128 v5, v[12:15] offset:4096
    s_waitcnt vmcnt(12)
    ds_write_b128 v5, v[16:19] offset:8192
    s_waitcnt vmcnt(11)
    ds_write_b128 v5, v[20:23] offset:12288
    s_waitcnt vmcnt(10)
    ds_write_b128 v5, v[24:27] offset:16384
    s_waitcnt vmcnt(9)
    ds_write_b128 v5, v[28:31] offset:20480
    s_waitcnt vmcnt(8)
    ds_write_b128 v5, v[32:35] offset:24576
    s_waitcnt vmcnt(7)
    ds_write_b128 v5, v[36:39] offset:28672
    s_waitcnt vmcnt(6)
    ds_write_b128 v5, v[40:43] offset:32768
    s_waitcnt vmcnt(0)
    v_add_f32 v104, 1.0, v104
    v_cvt_pk_bf16_f32 v104, v104, v104
    v_lshlrev_b32 v104, 16, v104
    ds_write_b32 v1, v104 offset:36864
    ds_write_b16_d16_hi v110, v100 offset:39168
    v_add_f32 v105, 1.0, v105
    v_cvt_pk_bf16_f32 v105, v105, v105
    v_lshlrev_b32 v105, 16, v105
    ds_write_b32 v1, v105 offset:37888
    ds_write_b16_d16_hi v110, v101 offset:39680
    v_add_f32 v106, 1.0, v106
    v_cvt_pk_bf16_f32 v106, v106, v106
    v_lshlrev_b32 v106, 16, v106
    v_cmp_gt_u32 vcc, 64, v0
    s_nop 0
    s_and_saveexec_b64 s[46:47], vcc
    ds_write_b32 v1, v106 offset:38912
    ds_write_b16_d16_hi v110, v102 offset:40192
    s_mov_b64 exec, s[46:47]
    s_waitcnt lgkmcnt(0)
    s_barrier
    ds_read_b64_tr_b16 v[48:49], v6 offset:0
    ds_read_b64_tr_b16 v[50:51], v6 offset:1024
    ds_read_b128 v[52:55], v7 offset:36864
    ds_read_b128 v[56:59], v7 offset:36928
    ds_read_b64 v[60:61], v108 offset:39168
    ds_read_b64 v[62:63], v108 offset:39200
    ds_read_b64_tr_b16 v[64:65], v6 offset:2048
    ds_read_b64_tr_b16 v[66:67], v6 offset:3072
    ds_read_b128 v[68:71], v7 offset:36992
    ds_read_b128 v[72:75], v7 offset:37056
    ds_read_b64 v[76:77], v108 offset:39232
    ds_read_b64 v[78:79], v108 offset:39264
    s_waitcnt lgkmcnt(6)
    v_mfma_f32_16x16x32_bf16 v[124:127], v[48:51], v[60:63], 0
    v_lshlrev_b32 v80, 16, v48
    v_and_b32 v81, 0xffff0000, v48
    v_lshlrev_b32 v82, 16, v49
    v_and_b32 v83, 0xffff0000, v49
    v_lshlrev_b32 v84, 16, v50
    v_and_b32 v85, 0xffff0000, v50
    v_lshlrev_b32 v86, 16, v51
    v_and_b32 v87, 0xffff0000, v51
    v_pk_mul_f32 v[80:81], v[80:81], v[52:53]
    v_pk_mul_f32 v[82:83], v[82:83], v[54:55]
    v_pk_mul_f32 v[84:85], v[84:85], v[56:57]
    v_pk_mul_f32 v[86:87], v[86:87], v[58:59]
    v_cvt_pk_bf16_f32 v8, v80, v81
    v_cvt_pk_bf16_f32 v9, v82, v83
    v_cvt_pk_bf16_f32 v10, v84, v85
    v_cvt_pk_bf16_f32 v11, v86, v87
    s_nop 1
    v_mfma_f32_16x16x32_bf16 v[120:123], v[8:11], v[112:115], 0
    buffer_store_dwordx4 v[8:11], v109, s[12:15], s29 offen sc1
    s_add_u32 s29, s29, s30
    ds_read_b64_tr_b16 v[48:49], v6 offset:4096
    ds_read_b64_tr_b16 v[50:51], v6 offset:5120
    ds_read_b128 v[52:55], v7 offset:37120
    ds_read_b128 v[56:59], v7 offset:37184
    ds_read_b64 v[60:61], v108 offset:39296
    ds_read_b64 v[62:63], v108 offset:39328
    s_waitcnt lgkmcnt(6)
    v_mfma_f32_16x16x32_bf16 v[124:127], v[64:67], v[76:79], v[124:127]
    v_lshlrev_b32 v80, 16, v64
    v_and_b32 v81, 0xffff0000, v64
    v_lshlrev_b32 v82, 16, v65
    v_and_b32 v83, 0xffff0000, v65
    v_lshlrev_b32 v84, 16, v66
    v_and_b32 v85, 0xffff0000, v66
    v_lshlrev_b32 v86, 16, v67
    v_and_b32 v87, 0xffff0000, v67
    v_pk_mul_f32 v[80:81], v[80:81], v[68:69]
    v_pk_mul_f32 v[82:83], v[82:83], v[70:71]
    v_pk_mul_f32 v[84:85], v[84:85], v[72:73]
    v_pk_mul_f32 v[86:87], v[86:87], v[74:75]
    v_cvt_pk_bf16_f32 v12, v80, v81
    v_cvt_pk_bf16_f32 v13, v82, v83
    v_cvt_pk_bf16_f32 v14, v84, v85
    v_cvt_pk_bf16_f32 v15, v86, v87
    s_nop 1
    v_mfma_f32_16x16x32_bf16 v[120:123], v[12:15], v[112:115], v[120:123]
    buffer_store_dwordx4 v[12:15], v109, s[12:15], s29 offen sc1
    s_add_u32 s29, s29, s30
    ds_read_b64_tr_b16 v[64:65], v6 offset:6144
    ds_read_b64_tr_b16 v[66:67], v6 offset:7168
    ds_read_b128 v[68:71], v7 offset:37248
    ds_read_b128 v[72:75], v7 offset:37312
    ds_read_b64 v[76:77], v108 offset:39360
    ds_read_b64 v[78:79], v108 offset:39392
    s_waitcnt lgkmcnt(6)
    v_mfma_f32_16x16x32_bf16 v[124:127], v[48:51], v[60:63], v[124:127]
    v_lshlrev_b32 v80, 16, v48
    v_and_b32 v81, 0xffff0000, v48
    v_lshlrev_b32 v82, 16, v49
    v_and_b32 v83, 0xffff0000, v49
    v_lshlrev_b32 v84, 16, v50
    v_and_b32 v85, 0xffff0000, v50
    v_lshlrev_b32 v86, 16, v51
    v_and_b32 v87, 0xffff0000, v51
    v_pk_mul_f32 v[80:81], v[80:81], v[52:53]
    v_pk_mul_f32 v[82:83], v[82:83], v[54:55]
    v_pk_mul_f32 v[84:85], v[84:85], v[56:57]
    v_pk_mul_f32 v[86:87], v[86:87], v[58:59]
    v_cvt_pk_bf16_f32 v16, v80, v81
    v_cvt_pk_bf16_f32 v17, v82, v83
    v_cvt_pk_bf16_f32 v18, v84, v85
    v_cvt_pk_bf16_f32 v19, v86, v87
    s_nop 1
    v_mfma_f32_16x16x32_bf16 v[120:123], v[16:19], v[112:115], v[120:123]
    buffer_store_dwordx4 v[16:19], v109, s[12:15], s29 offen sc1
    s_add_u32 s29, s29, s30
    ds_read_b64_tr_b16 v[48:49], v6 offset:8192
    ds_read_b64_tr_b16 v[50:51], v6 offset:9216
    ds_read_b128 v[52:55], v7 offset:37376
    ds_read_b128 v[56:59], v7 offset:37440
    ds_read_b64 v[60:61], v108 offset:39424
    ds_read_b64 v[62:63], v108 offset:39456
    s_waitcnt lgkmcnt(6)
    v_mfma_f32_16x16x32_bf16 v[124:127], v[64:67], v[76:79], v[124:127]
    v_lshlrev_b32 v80, 16, v64
    v_and_b32 v81, 0xffff0000, v64
    v_lshlrev_b32 v82, 16, v65
    v_and_b32 v83, 0xffff0000, v65
    v_lshlrev_b32 v84, 16, v66
    v_and_b32 v85, 0xffff0000, v66
    v_lshlrev_b32 v86, 16, v67
    v_and_b32 v87, 0xffff0000, v67
    v_pk_mul_f32 v[80:81], v[80:81], v[68:69]
    v_pk_mul_f32 v[82:83], v[82:83], v[70:71]
    v_pk_mul_f32 v[84:85], v[84:85], v[72:73]
    v_pk_mul_f32 v[86:87], v[86:87], v[74:75]
    v_cvt_pk_bf16_f32 v20, v80, v81
    v_cvt_pk_bf16_f32 v21, v82, v83
    v_cvt_pk_bf16_f32 v22, v84, v85
    v_cvt_pk_bf16_f32 v23, v86, v87
    s_nop 1
    v_mfma_f32_16x16x32_bf16 v[120:123], v[20:23], v[112:115], v[120:123]
    buffer_store_dwordx4 v[20:23], v109, s[12:15], s29 offen sc1
    s_add_u32 s29, s29, s30
    ds_read_b64_tr_b16 v[64:65], v6 offset:10240
    ds_read_b64_tr_b16 v[66:67], v6 offset:11264
    ds_read_b128 v[68:71], v7 offset:37504
    ds_read_b128 v[72:75], v7 offset:37568
    ds_read_b64 v[76:77], v108 offset:39488
    ds_read_b64 v[78:79], v108 offset:39520
    s_waitcnt lgkmcnt(6)
    v_mfma_f32_16x16x32_bf16 v[124:127], v[48:51], v[60:63], v[124:127]
    v_lshlrev_b32 v80, 16, v48
    v_and_b32 v81, 0xffff0000, v48
    v_lshlrev_b32 v82, 16, v49
    v_and_b32 v83, 0xffff0000, v49
    v_lshlrev_b32 v84, 16, v50
    v_and_b32 v85, 0xffff0000, v50
    v_lshlrev_b32 v86, 16, v51
    v_and_b32 v87, 0xffff0000, v51
    v_pk_mul_f32 v[80:81], v[80:81], v[52:53]
    v_pk_mul_f32 v[82:83], v[82:83], v[54:55]
    v_pk_mul_f32 v[84:85], v[84:85], v[56:57]
    v_pk_mul_f32 v[86:87], v[86:87], v[58:59]
    v_cvt_pk_bf16_f32 v24, v80, v81
    v_cvt_pk_bf16_f32 v25, v82, v83
    v_cvt_pk_bf16_f32 v26, v84, v85
    v_cvt_pk_bf16_f32 v27, v86, v87
    s_nop 1
    v_mfma_f32_16x16x32_bf16 v[120:123], v[24:27], v[112:115], v[120:123]
    buffer_store_dwordx4 v[24:27], v109, s[12:15], s29 offen sc1
    s_add_u32 s29, s29, s30
    ds_read_b64_tr_b16 v[48:49], v6 offset:12288
    ds_read_b64_tr_b16 v[50:51], v6 offset:13312
    ds_read_b128 v[52:55], v7 offset:37632
    ds_read_b128 v[56:59], v7 offset:37696
    ds_read_b64 v[60:61], v108 offset:39552
    ds_read_b64 v[62:63], v108 offset:39584
    s_waitcnt lgkmcnt(6)
    v_mfma_f32_16x16x32_bf16 v[124:127], v[64:67], v[76:79], v[124:127]
    v_lshlrev_b32 v80, 16, v64
    v_and_b32 v81, 0xffff0000, v64
    v_lshlrev_b32 v82, 16, v65
    v_and_b32 v83, 0xffff0000, v65
    v_lshlrev_b32 v84, 16, v66
    v_and_b32 v85, 0xffff0000, v66
    v_lshlrev_b32 v86, 16, v67
    v_and_b32 v87, 0xffff0000, v67
    v_pk_mul_f32 v[80:81], v[80:81], v[68:69]
    v_pk_mul_f32 v[82:83], v[82:83], v[70:71]
    v_pk_mul_f32 v[84:85], v[84:85], v[72:73]
    v_pk_mul_f32 v[86:87], v[86:87], v[74:75]
    v_cvt_pk_bf16_f32 v28, v80, v81
    v_cvt_pk_bf16_f32 v29, v82, v83
    v_cvt_pk_bf16_f32 v30, v84, v85
    v_cvt_pk_bf16_f32 v31, v86, v87
    s_nop 1
    v_mfma_f32_16x16x32_bf16 v[120:123], v[28:31], v[112:115], v[120:123]
    buffer_store_dwordx4 v[28:31], v109, s[12:15], s29 offen sc1
    s_add_u32 s29, s29, s30
    ds_read_b64_tr_b16 v[64:65], v6 offset:14336
    ds_read_b64_tr_b16 v[66:67], v6 offset:15360
    ds_read_b128 v[68:71], v7 offset:37760
    ds_read_b128 v[72:75], v7 offset:37824
    ds_read_b64 v[76:77], v108 offset:39616
    ds_read_b64 v[78:79], v108 offset:39648
    s_waitcnt lgkmcnt(6)
    v_mfma_f32_16x16x32_bf16 v[124:127], v[48:51], v[60:63], v[124:127]
    v_lshlrev_b32 v80, 16, v48
    v_and_b32 v81, 0xffff0000, v48
    v_lshlrev_b32 v82, 16, v49
    v_and_b32 v83, 0xffff0000, v49
    v_lshlrev_b32 v84, 16, v50
    v_and_b32 v85, 0xffff0000, v50
    v_lshlrev_b32 v86, 16, v51
    v_and_b32 v87, 0xffff0000, v51
    v_pk_mul_f32 v[80:81], v[80:81], v[52:53]
    v_pk_mul_f32 v[82:83], v[82:83], v[54:55]
    v_pk_mul_f32 v[84:85], v[84:85], v[56:57]
    v_pk_mul_f32 v[86:87], v[86:87], v[58:59]
    v_cvt_pk_bf16_f32 v32, v80, v81
    v_cvt_pk_bf16_f32 v33, v82, v83
    v_cvt_pk_bf16_f32 v34, v84, v85
    v_cvt_pk_bf16_f32 v35, v86, v87
    s_nop 1
    v_mfma_f32_16x16x32_bf16 v[120:123], v[32:35], v[112:115], v[120:123]
    buffer_store_dwordx4 v[32:35], v109, s[12:15], s29 offen sc1
    s_add_u32 s29, s29, s30
    ds_read_b64_tr_b16 v[48:49], v6 offset:16384
    ds_read_b64_tr_b16 v[50:51], v6 offset:17408
    ds_read_b128 v[52:55], v7 offset:37888
    ds_read_b128 v[56:59], v7 offset:37952
    ds_read_b64 v[60:61], v108 offset:39680
    ds_read_b64 v[62:63], v108 offset:39712
    s_waitcnt lgkmcnt(6)
    v_mfma_f32_16x16x32_bf16 v[124:127], v[64:67], v[76:79], v[124:127]
    v_lshlrev_b32 v80, 16, v64
    v_and_b32 v81, 0xffff0000, v64
    v_lshlrev_b32 v82, 16, v65
    v_and_b32 v83, 0xffff0000, v65
    v_lshlrev_b32 v84, 16, v66
    v_and_b32 v85, 0xffff0000, v66
    v_lshlrev_b32 v86, 16, v67
    v_and_b32 v87, 0xffff0000, v67
    v_pk_mul_f32 v[80:81], v[80:81], v[68:69]
    v_pk_mul_f32 v[82:83], v[82:83], v[70:71]
    v_pk_mul_f32 v[84:85], v[84:85], v[72:73]
    v_pk_mul_f32 v[86:87], v[86:87], v[74:75]
    v_cvt_pk_bf16_f32 v36, v80, v81
    v_cvt_pk_bf16_f32 v37, v82, v83
    v_cvt_pk_bf16_f32 v38, v84, v85
    v_cvt_pk_bf16_f32 v39, v86, v87
    s_nop 1
    v_mfma_f32_16x16x32_bf16 v[120:123], v[36:39], v[112:115], v[120:123]
    buffer_store_dwordx4 v[36:39], v109, s[12:15], s29 offen sc1
    s_add_u32 s29, s29, s30
    s_waitcnt lgkmcnt(0)
    v_mfma_f32_16x16x32_bf16 v[124:127], v[48:51], v[60:63], v[124:127]
    v_lshlrev_b32 v80, 16, v48
    v_and_b32 v81, 0xffff0000, v48
    v_lshlrev_b32 v82, 16, v49
    v_and_b32 v83, 0xffff0000, v49
    v_lshlrev_b32 v84, 16, v50
    v_and_b32 v85, 0xffff0000, v50
    v_lshlrev_b32 v86, 16, v51
    v_and_b32 v87, 0xffff0000, v51
    v_pk_mul_f32 v[80:81], v[80:81], v[52:53]
    v_pk_mul_f32 v[82:83], v[82:83], v[54:55]
    v_pk_mul_f32 v[84:85], v[84:85], v[56:57]
    v_pk_mul_f32 v[86:87], v[86:87], v[58:59]
    v_cvt_pk_bf16_f32 v40, v80, v81
    v_cvt_pk_bf16_f32 v41, v82, v83
    v_cvt_pk_bf16_f32 v42, v84, v85
    v_cvt_pk_bf16_f32 v43, v86, v87
    s_nop 1
    v_mfma_f32_16x16x32_bf16 v[120:123], v[40:43], v[112:115], v[120:123]
    buffer_store_dwordx4 v[40:43], v109, s[12:15], s29 offen sc1
    s_add_u32 s29, s29, s30
    s_barrier
    v_and_b32 v1, 127, v0
    v_lshlrev_b32 v1, 5, v1
    v_readfirstlane_b32 s45, v111
    s_nop 0
    s_cmp_eq_u32 s45, 0
    s_cbranch_scc1 K2_W1_A
    ds_write_b128 v1, v[120:123]
    ds_write_b128 v1, v[124:127] offset:16
    s_waitcnt lgkmcnt(0)
    s_barrier
    s_endpgm
K2_W1_A:
    s_barrier
    ds_read_b128 v[48:51], v1
    ds_read_b128 v[52:55], v1 offset:16
    v_and_b32 v2, 15, v0
    v_cmp_eq_u32 vcc, 0, v2
    s_lshl_b32 s24, s3, 7
    s_waitcnt lgkmcnt(0)
    v_pk_add_f32 v[120:121], v[120:121], v[48:49]
    v_pk_add_f32 v[122:123], v[122:123], v[50:51]
    v_pk_add_f32 v[124:125], v[124:125], v[52:53]
    v_pk_add_f32 v[126:127], v[126:127], v[54:55]
    v_mul_f32 v124, 0xbfb8aa3b, v124
    v_mul_f32 v125, 0xbfb8aa3b, v125
    v_mul_f32 v126, 0xbfb8aa3b, v126
    v_mul_f32 v127, 0xbfb8aa3b, v127
    s_and_saveexec_b64 s[46:47], vcc
    buffer_store_dwordx4 v[120:123], v0, s[36:39], s24 offen
    buffer_store_dwordx4 v[124:127], v0, s[40:43], s24 offen
    s_endpgm

.globl k3_kernel
.p2align 8
.type k3_kernel,@function
k3_kernel:
    s_cmp_ge_u32 s2, 256
    s_cbranch_scc1 KF_END
    s_load_dwordx2 s[4:5], s[0:1], 112
    s_and_b32 s23, s2, 7
    s_lshr_b32 s24, s2, 3
    s_and_b32 s20, s23, 3
    s_lshl_b32 s20, s20, 1
    s_and_b32 s25, s24, 1
    s_add_u32 s20, s20, s25
    s_lshr_b32 s21, s23, 2
    s_lshl_b32 s21, s21, 4
    s_lshr_b32 s25, s24, 1
    s_add_u32 s21, s21, s25
    v_and_b32 v1, 63, v0
    v_lshrrev_b32 v2, 6, v0
    s_nop 0
    v_readfirstlane_b32 s22, v2
    v_lshlrev_b32 v3, 4, v1
    v_lshrrev_b32 v60, 4, v1
    v_and_b32 v61, 15, v1
    v_lshrrev_b32 v8, 3, v1
    v_lshlrev_b32 v8, 7, v8
    v_and_b32 v56, 7, v1
    v_lshlrev_b32 v57, 1, v60
    v_xor_b32 v56, v56, v57
    v_lshl_add_u32 v8, v56, 4, v8
    s_mul_i32 s23, s21, 73728
    s_mul_i32 s33, s22, 6144
    s_add_u32 s23, s23, s33
    s_mul_i32 s24, s20, 12
    s_add_u32 s24, s24, s22
    s_mul_i32 s25, s24, 55296
    s_add_u32 s26, s25, 8388608
    v_lshlrev_b32 v23, 4, v0
    s_waitcnt lgkmcnt(0)
    s_add_u32 s12, s4, 0xc00000
    s_addc_u32 s13, s5, 0
    s_mov_b32 s14, 0x240000
    s_mov_b32 s15, 0x00020000
    s_mov_b32 m0, s33
    s_nop 0
    buffer_load_dwordx4 v8, s[12:15], s23 offen offset:0 lds
    buffer_load_dwordx4 v8, s[12:15], s23 offen offset:1024 lds
    buffer_load_dwordx4 v8, s[12:15], s23 offen offset:2048 lds
    buffer_load_dwordx4 v8, s[12:15], s23 offen offset:3072 lds
    s_add_u32 m0, s33, 4096
    s_add_u32 s23, s23, 4096
    buffer_load_dwordx4 v8, s[12:15], s23 offen offset:0 lds
    buffer_load_dwordx4 v8, s[12:15], s23 offen offset:1024 lds
    s_add_u32 s44, s4, 0x10000
    s_addc_u32 s45, s5, 0
    s_mov_b32 s46, 0x14800
    s_mov_b32 s47, 0x00020000
    v_cmp_le_u32 vcc, 144, v0
    v_mov_b32 v56, 63232
    s_nop 0
    v_cndmask_b32 v56, 0, v56, vcc
    v_add_u32 v56, v56, v23
    s_mul_i32 s30, s20, 2304
    buffer_load_dwordx4 v[64:67], v56, s[44:47], s30 offen
    s_add_u32 s8, s4, 0x1000000
    s_addc_u32 s9, s5, 0
    s_mov_b32 s10, 0xd10000
    s_mov_b32 s11, 0x00020000
    s_barrier
    buffer_load_dwordx4 v[104:107], v3, s[8:11], s25 offen offset:0
    buffer_load_dwordx4 v[108:111], v3, s[8:11], s25 offen offset:1024
    buffer_load_dwordx4 v[112:115], v3, s[8:11], s25 offen offset:2048
    s_add_u32 s25, s25, 3072
    v_lshrrev_b32 v56, 1, v60
    v_lshlrev_b32 v56, 10, v56
    v_and_b32 v57, 1, v60
    v_lshrrev_b32 v58, 2, v61
    v_lshl_add_u32 v58, v57, 2, v58
    v_lshl_add_u32 v56, v58, 7, v56
    v_and_b32 v59, 3, v61
    v_lshl_add_u32 v56, v59, 3, v56
    v_lshrrev_b32 v58, 1, v58
    v_lshlrev_b32 v58, 5, v58
    v_xor_b32 v10, 0, v58
    v_add_u32 v10, v56, v10
    v_xor_b32 v11, 32, v58
    v_add_u32 v11, v56, v11
    v_xor_b32 v12, 64, v58
    v_add_u32 v12, v56, v12
    v_xor_b32 v13, 96, v58
    v_add_u32 v13, v56, v13
    s_and_b32 s30, s22, 3
    s_lshl_b32 s31, s30, 5
    v_xor_b32 v18, s31, v58
    v_add_u32 v18, v56, v18
    s_lshr_b32 s31, s22, 2
    s_mul_i32 s34, s31, 24576
    v_add_u32 v18, s34, v18
    v_lshlrev_b32 v6, 3, v61
    v_add_u32 v6, 152576, v6
    s_lshl_b32 s31, s31, 9
    s_lshl_b32 s30, s30, 7
    s_add_u32 s30, s30, s31
    v_add_u32 v7, s30, v6
    v_add_u32 v4, 73728, v3
    s_mul_i32 s30, s22, 3
    s_add_u32 s30, s30, 0
    s_lshr_b32 s31, s30, 1
    s_lshl_b32 s31, s31, 12
    s_and_b32 s30, s30, 1
    s_lshl_b32 s30, s30, 3
    s_add_u32 s30, s30, s31
    v_add_u32 v19, s30, v4
    s_mul_i32 s30, s22, 3
    s_add_u32 s30, s30, 1
    s_lshr_b32 s31, s30, 1
    s_lshl_b32 s31, s31, 12
    s_and_b32 s30, s30, 1
    s_lshl_b32 s30, s30, 3
    s_add_u32 s30, s30, s31
    v_add_u32 v20, s30, v4
    s_mul_i32 s30, s22, 3
    s_add_u32 s30, s30, 2
    s_lshr_b32 s31, s30, 1
    s_lshl_b32 s31, s31, 12
    s_and_b32 s30, s30, 1
    s_lshl_b32 s30, s30, 3
    s_add_u32 s30, s30, s31
    v_add_u32 v21, s30, v4
    s_mul_i32 s30, s22, 192
    s_add_u32 s30, s30, 147968
    v_lshl_add_u32 v22, v60, 4, s30
    v_add_u32 v23, 147968, v23
    v_and_b32 v9, 3, v1
    v_cmp_eq_u32 s[50:51], 1, v9
    v_cmp_eq_u32 s[52:53], 2, v9
    v_cmp_eq_u32 s[54:55], 3, v9
    v_lshrrev_b32 v9, 2, v61
    v_cmp_eq_u32 s[56:57], v9, v60
    v_mov_b32 v68, 0x3f803f80
    v_mov_b32 v69, 0x3f803f80
    v_mov_b32 v70, 0x3f803f80
    v_mov_b32 v71, 0x3f803f80
    s_add_u32 s16, s4, 0x2000000
    s_addc_u32 s17, s5, 0
    s_mov_b32 s18, 0x1200000
    s_mov_b32 s19, 0x00020000
    s_lshl_b32 s34, s20, 5
    s_add_u32 s34, s34, s21
    s_mul_i32 s34, s34, 73728
    s_add_u32 s34, s34, s33
    s_add_u32 s35, s34, 4096
    s_waitcnt vmcnt(3)
    v_cmp_gt_u32 vcc, 288, v0
    s_nop 0
    s_and_saveexec_b64 s[58:59], vcc
    ds_write_b128 v23, v[64:67]
    s_mov_b64 exec, s[58:59]
    s_lshl_b32 s30, s22, 2
    s_add_u32 s30, s30, 154112
    v_mov_b32 v5, s30
    v_mov_b32 v9, 0
    ds_write_b32 v5, v9
    ds_write_b32 v5, v9 offset:64
    s_waitcnt lgkmcnt(0)
    s_barrier
    ds_read_b64_tr_b16 v[80:81], v18 offset:0
    ds_read_b64_tr_b16 v[82:83], v18 offset:2048
    ds_read_b64_tr_b16 v[84:85], v18 offset:4096
    ds_read_b64_tr_b16 v[86:87], v18 offset:6144
    ds_read_b64_tr_b16 v[88:89], v18 offset:8192
    ds_read_b64_tr_b16 v[90:91], v18 offset:10240
    ds_read_b64_tr_b16 v[92:93], v18 offset:12288
    ds_read_b64_tr_b16 v[94:95], v18 offset:14336
    ds_read_b64_tr_b16 v[96:97], v18 offset:16384
    ds_read_b64_tr_b16 v[98:99], v18 offset:18432
    ds_read_b64_tr_b16 v[100:101], v18 offset:20480
    ds_read_b64_tr_b16 v[102:103], v18 offset:22528
    s_waitcnt lgkmcnt(10)
    v_mfma_f32_16x16x32_bf16 v[72:75], v[68:71], v[80:83], 0
    v_mfma_f32_16x16x32_bf16 v[76:79], v[80:83], v[80:83], 0
    s_waitcnt lgkmcnt(8)
    v_mfma_f32_16x16x32_bf16 v[72:75], v[68:71], v[84:87], v[72:75]
    v_mfma_f32_16x16x32_bf16 v[76:79], v[84:87], v[84:87], v[76:79]
    s_waitcnt lgkmcnt(6)
    v_mfma_f32_16x16x32_bf16 v[72:75], v[68:71], v[88:91], v[72:75]
    v_mfma_f32_16x16x32_bf16 v[76:79], v[88:91], v[88:91], v[76:79]
    s_waitcnt lgkmcnt(4)
    v_mfma_f32_16x16x32_bf16 v[72:75], v[68:71], v[92:95], v[72:75]
    v_mfma_f32_16x16x32_bf16 v[76:79], v[92:95], v[92:95], v[76:79]
    s_waitcnt lgkmcnt(2)
    v_mfma_f32_16x16x32_bf16 v[72:75], v[68:71], v[96:99], v[72:75]
    v_mfma_f32_16x16x32_bf16 v[76:79], v[96:99], v[96:99], v[76:79]
    s_waitcnt lgkmcnt(0)
    v_mfma_f32_16x16x32_bf16 v[72:75], v[68:71], v[100:103], v[72:75]
    v_mfma_f32_16x16x32_bf16 v[76:79], v[100:103], v[100:103], v[76:79]
    ds_read_b64_tr_b16 v[24:25], v10 offset:0
    ds_read_b64_tr_b16 v[26:27], v10 offset:2048
    ds_read_b64_tr_b16 v[28:29], v11 offset:0
    ds_read_b64_tr_b16 v[30:31], v11 offset:2048
    ds_read_b64_tr_b16 v[32:33], v12 offset:0
    ds_read_b64_tr_b16 v[34:35], v12 offset:2048
    ds_read_b64_tr_b16 v[36:37], v13 offset:0
    ds_read_b64_tr_b16 v[38:39], v13 offset:2048
    v_cndmask_b32 v76, v76, v77, s[50:51]
    v_cndmask_b32 v76, v76, v78, s[52:53]
    v_cndmask_b32 v73, v76, v79, s[54:55]
    s_mov_b64 exec, s[56:57]
    ds_write_b64 v7, v[72:73]
    s_mov_b64 exec, -1
    v_mov_b32 v9, 1
    s_waitcnt lgkmcnt(0)
    ds_write_b32 v5, v9 offset:64
    buffer_load_dwordx4 v[116:119], v3, s[8:11], s25 offen offset:0
    buffer_load_dwordx4 v[120:123], v3, s[8:11], s25 offen offset:1024
    buffer_load_dwordx4 v[124:127], v3, s[8:11], s25 offen offset:2048
    s_add_u32 s25, s25, 3072
    buffer_load_dwordx4 v[128:131], v3, s[8:11], s25 offen offset:0
    buffer_load_dwordx4 v[132:135], v3, s[8:11], s25 offen offset:1024
    buffer_load_dwordx4 v[136:139], v3, s[8:11], s25 offen offset:2048
    s_add_u32 s25, s25, 3072
    buffer_load_dwordx4 v[140:143], v3, s[8:11], s25 offen offset:0
    buffer_load_dwordx4 v[144:147], v3, s[8:11], s25 offen offset:1024
    buffer_load_dwordx4 v[148:151], v3, s[8:11], s25 offen offset:2048
    s_add_u32 s25, s25, 3072
    buffer_load_dwordx4 v[152:155], v3, s[8:11], s25 offen offset:0
    buffer_load_dwordx4 v[156:159], v3, s[8:11], s25 offen offset:1024
    buffer_load_dwordx4 v[160:163], v3, s[8:11], s25 offen offset:2048
    s_add_u32 s25, s25, 3072
    s_waitcnt vmcnt(12) lgkmcnt(0)
    v_mfma_f32_16x16x32_bf16 v[56:59], v[104:107], v[24:27], 0
    ds_read_b64_tr_b16 v[40:41], v10 offset:4096
    ds_read_b64_tr_b16 v[42:43], v10 offset:6144
    v_mfma_f32_16x16x32_bf16 v[60:63], v[104:107], v[28:31], 0
    ds_read_b64_tr_b16 v[44:45], v11 offset:4096
    ds_read_b64_tr_b16 v[46:47], v11 offset:6144
    v_mfma_f32_16x16x32_bf16 v[64:67], v[104:107], v[32:35], 0
    ds_read_b64_tr_b16 v[48:49], v12 offset:4096
    ds_read_b64_tr_b16 v[50:51], v12 offset:6144
    v_mfma_f32_16x16x32_bf16 v[68:71], v[104:107], v[36:39], 0
    ds_read_b64_tr_b16 v[52:53], v13 offset:4096
    ds_read_b64_tr_b16 v[54:55], v13 offset:6144
    buffer_load_dwordx4 v[104:107], v3, s[8:11], s25 offen offset:0
    v_mfma_f32_16x16x32_bf16 v[72:75], v[108:111], v[24:27], 0
    v_mfma_f32_16x16x32_bf16 v[76:79], v[108:111], v[28:31], 0
    v_mfma_f32_16x16x32_bf16 v[80:83], v[108:111], v[32:35], 0
    v_mfma_f32_16x16x32_bf16 v[84:87], v[108:111], v[36:39], 0
    buffer_load_dwordx4 v[108:111], v3, s[8:11], s25 offen offset:1024
    v_mfma_f32_16x16x32_bf16 v[88:91], v[112:115], v[24:27], 0
    v_mfma_f32_16x16x32_bf16 v[92:95], v[112:115], v[28:31], 0
    v_mfma_f32_16x16x32_bf16 v[96:99], v[112:115], v[32:35], 0
    v_mfma_f32_16x16x32_bf16 v[100:103], v[112:115], v[36:39], 0
    buffer_load_dwordx4 v[112:115], v3, s[8:11], s25 offen offset:2048
    s_add_u32 s25, s25, 3072
    s_waitcnt vmcnt(12) lgkmcnt(0)
    v_mfma_f32_16x16x32_bf16 v[56:59], v[116:119], v[40:43], v[56:59]
    ds_read_b64_tr_b16 v[24:25], v10 offset:8192
    ds_read_b64_tr_b16 v[26:27], v10 offset:10240
    v_mfma_f32_16x16x32_bf16 v[60:63], v[116:119], v[44:47], v[60:63]
    ds_read_b64_tr_b16 v[28:29], v11 offset:8192
    ds_read_b64_tr_b16 v[30:31], v11 offset:10240
    v_mfma_f32_16x16x32_bf16 v[64:67], v[116:119], v[48:51], v[64:67]
    ds_read_b64_tr_b16 v[32:33], v12 offset:8192
    ds_read_b64_tr_b16 v[34:35], v12 offset:10240
    v_mfma_f32_16x16x32_bf16 v[68:71], v[116:119], v[52:55], v[68:71]
    ds_read_b64_tr_b16 v[36:37], v13 offset:8192
    ds_read_b64_tr_b16 v[38:39], v13 offset:10240
    buffer_load_dwordx4 v[116:119], v3, s[8:11], s25 offen offset:0
    v_mfma_f32_16x16x32_bf16 v[72:75], v[120:123], v[40:43], v[72:75]
    v_mfma_f32_16x16x32_bf16 v[76:79], v[120:123], v[44:47], v[76:79]
    v_mfma_f32_16x16x32_bf16 v[80:83], v[120:123], v[48:51], v[80:83]
    v_mfma_f32_16x16x32_bf16 v[84:87], v[120:123], v[52:55], v[84:87]
    buffer_load_dwordx4 v[120:123], v3, s[8:11], s25 offen offset:1024
    v_mfma_f32_16x16x32_bf16 v[88:91], v[124:127], v[40:43], v[88:91]
    v_mfma_f32_16x16x32_bf16 v[92:95], v[124:127], v[44:47], v[92:95]
    v_mfma_f32_16x16x32_bf16 v[96:99], v[124:127], v[48:51], v[96:99]
    v_mfma_f32_16x16x32_bf16 v[100:103], v[124:127], v[52:55], v[100:103]
    buffer_load_dwordx4 v[124:127], v3, s[8:11], s25 offen offset:2048
    s_add_u32 s25, s25, 3072
    s_waitcnt vmcnt(12) lgkmcnt(0)
    v_mfma_f32_16x16x32_bf16 v[56:59], v[128:131], v[24:27], v[56:59]
    ds_read_b64_tr_b16 v[40:41], v10 offset:12288
    ds_read_b64_tr_b16 v[42:43], v10 offset:14336
    v_mfma_f32_16x16x32_bf16 v[60:63], v[128:131], v[28:31], v[60:63]
    ds_read_b64_tr_b16 v[44:45], v11 offset:12288
    ds_read_b64_tr_b16 v[46:47], v11 offset:14336
    v_mfma_f32_16x16x32_bf16 v[64:67], v[128:131], v[32:35], v[64:67]
    ds_read_b64_tr_b16 v[48:49], v12 offset:12288
    ds_read_b64_tr_b16 v[50:51], v12 offset:14336
    v_mfma_f32_16x16x32_bf16 v[68:71], v[128:131], v[36:39], v[68:71]
    ds_read_b64_tr_b16 v[52:53], v13 offset:12288
    ds_read_b64_tr_b16 v[54:55], v13 offset:14336
    buffer_load_dwordx4 v[128:131], v3, s[8:11], s25 offen offset:0
    v_mfma_f32_16x16x32_bf16 v[72:75], v[132:135], v[24:27], v[72:75]
    v_mfma_f32_16x16x32_bf16 v[76:79], v[132:135], v[28:31], v[76:79]
    v_mfma_f32_16x16x32_bf16 v[80:83], v[132:135], v[32:35], v[80:83]
    v_mfma_f32_16x16x32_bf16 v[84:87], v[132:135], v[36:39], v[84:87]
    buffer_load_dwordx4 v[132:135], v3, s[8:11], s25 offen offset:1024
    v_mfma_f32_16x16x32_bf16 v[88:91], v[136:139], v[24:27], v[88:91]
    v_mfma_f32_16x16x32_bf16 v[92:95], v[136:139], v[28:31], v[92:95]
    v_mfma_f32_16x16x32_bf16 v[96:99], v[136:139], v[32:35], v[96:99]
    v_mfma_f32_16x16x32_bf16 v[100:103], v[136:139], v[36:39], v[100:103]
    buffer_load_dwordx4 v[136:139], v3, s[8:11], s25 offen offset:2048
    s_add_u32 s25, s25, 3072
    s_waitcnt vmcnt(12) lgkmcnt(0)
    v_mfma_f32_16x16x32_bf16 v[56:59], v[140:143], v[40:43], v[56:59]
    ds_read_b64_tr_b16 v[24:25], v10 offset:16384
    ds_read_b64_tr_b16 v[26:27], v10 offset:18432
    v_mfma_f32_16x16x32_bf16 v[60:63], v[140:143], v[44:47], v[60:63]
    ds_read_b64_tr_b16 v[28:29], v11 offset:16384
    ds_read_b64_tr_b16 v[30:31], v11 offset:18432
    v_mfma_f32_16x16x32_bf16 v[64:67], v[140:143], v[48:51], v[64:67]
    ds_read_b64_tr_b16 v[32:33], v12 offset:16384
    ds_read_b64_tr_b16 v[34:35], v12 offset:18432
    v_mfma_f32_16x16x32_bf16 v[68:71], v[140:143], v[52:55], v[68:71]
    ds_read_b64_tr_b16 v[36:37], v13 offset:16384
    ds_read_b64_tr_b16 v[38:39], v13 offset:18432
    buffer_load_dwordx4 v[140:143], v3, s[8:11], s25 offen offset:0
    v_mfma_f32_16x16x32_bf16 v[72:75], v[144:147], v[40:43], v[72:75]
    v_mfma_f32_16x16x32_bf16 v[76:79], v[144:147], v[44:47], v[76:79]
    v_mfma_f32_16x16x32_bf16 v[80:83], v[144:147], v[48:51], v[80:83]
    v_mfma_f32_16x16x32_bf16 v[84:87], v[144:147], v[52:55], v[84:87]
    buffer_load_dwordx4 v[144:147], v3, s[8:11], s25 offen offset:1024
    v_mfma_f32_16x16x32_bf16 v[88:91], v[148:151], v[40:43], v[88:91]
    v_mfma_f32_16x16x32_bf16 v[92:95], v[148:151], v[44:47], v[92:95]
    v_mfma_f32_16x16x32_bf16 v[96:99], v[148:151], v[48:51], v[96:99]
    v_mfma_f32_16x16x32_bf16 v[100:103], v[148:151], v[52:55], v[100:103]
    buffer_load_dwordx4 v[148:151], v3, s[8:11], s25 offen offset:2048
    s_add_u32 s25, s25, 3072
    s_waitcnt vmcnt(12) lgkmcnt(0)
    v_mfma_f32_16x16x32_bf16 v[56:59], v[152:155], v[24:27], v[56:59]
    ds_read_b64_tr_b16 v[40:41], v10 offset:20480
    ds_read_b64_tr_b16 v[42:43], v10 offset:22528
    v_mfma_f32_16x16x32_bf16 v[60:63], v[152:155], v[28:31], v[60:63]
    ds_read_b64_tr_b16 v[44:45], v11 offset:20480
    ds_read_b64_tr_b16 v[46:47], v11 offset:22528
    v_mfma_f32_16x16x32_bf16 v[64:67], v[152:155], v[32:35], v[64:67]
    ds_read_b64_tr_b16 v[48:49], v12 offset:20480
    ds_read_b64_tr_b16 v[50:51], v12 offset:22528
    v_mfma_f32_16x16x32_bf16 v[68:71], v[152:155], v[36:39], v[68:71]
    ds_read_b64_tr_b16 v[52:53], v13 offset:20480
    ds_read_b64_tr_b16 v[54:55], v13 offset:22528
    buffer_load_dwordx4 v[152:155], v3, s[8:11], s25 offen offset:0
    v_mfma_f32_16x16x32_bf16 v[72:75], v[156:159], v[24:27], v[72:75]
    v_mfma_f32_16x16x32_bf16 v[76:79], v[156:159], v[28:31], v[76:79]
    v_mfma_f32_16x16x32_bf16 v[80:83], v[156:159], v[32:35], v[80:83]
    v_mfma_f32_16x16x32_bf16 v[84:87], v[156:159], v[36:39], v[84:87]
    buffer_load_dwordx4 v[156:159], v3, s[8:11], s25 offen offset:1024
    v_mfma_f32_16x16x32_bf16 v[88:91], v[160:163], v[24:27], v[88:91]
    v_mfma_f32_16x16x32_bf16 v[92:95], v[160:163], v[28:31], v[92:95]
    v_mfma_f32_16x16x32_bf16 v[96:99], v[160:163], v[32:35], v[96:99]
    v_mfma_f32_16x16x32_bf16 v[100:103], v[160:163], v[36:39], v[100:103]
    buffer_load_dwordx4 v[160:163], v3, s[8:11], s25 offen offset:2048
    s_add_u32 s25, s25, 3072
    s_waitcnt vmcnt(12) lgkmcnt(0)
    v_mfma_f32_16x16x32_bf16 v[56:59], v[104:107], v[40:43], v[56:59]
    ds_read_b64_tr_b16 v[24:25], v10 offset:24576
    ds_read_b64_tr_b16 v[26:27], v10 offset:26624
    v_mfma_f32_16x16x32_bf16 v[60:63], v[104:107], v[44:47], v[60:63]
    ds_read_b64_tr_b16 v[28:29], v11 offset:24576
    ds_read_b64_tr_b16 v[30:31], v11 offset:26624
    v_mfma_f32_16x16x32_bf16 v[64:67], v[104:107], v[48:51], v[64:67]
    ds_read_b64_tr_b16 v[32:33], v12 offset:24576
    ds_read_b64_tr_b16 v[34:35], v12 offset:26624
    v_mfma_f32_16x16x32_bf16 v[68:71], v[104:107], v[52:55], v[68:71]
    ds_read_b64_tr_b16 v[36:37], v13 offset:24576
    ds_read_b64_tr_b16 v[38:39], v13 offset:26624
    buffer_load_dwordx4 v[104:107], v3, s[8:11], s25 offen offset:0
    v_mfma_f32_16x16x32_bf16 v[72:75], v[108:111], v[40:43], v[72:75]
    v_mfma_f32_16x16x32_bf16 v[76:79], v[108:111], v[44:47], v[76:79]
    v_mfma_f32_16x16x32_bf16 v[80:83], v[108:111], v[48:51], v[80:83]
    v_mfma_f32_16x16x32_bf16 v[84:87], v[108:111], v[52:55], v[84:87]
    buffer_load_dwordx4 v[108:111], v3, s[8:11], s25 offen offset:1024
    v_mfma_f32_16x16x32_bf16 v[88:91], v[112:115], v[40:43], v[88:91]
    v_mfma_f32_16x16x32_bf16 v[92:95], v[112:115], v[44:47], v[92:95]
    v_mfma_f32_16x16x32_bf16 v[96:99], v[112:115], v[48:51], v[96:99]
    v_mfma_f32_16x16x32_bf16 v[100:103], v[112:115], v[52:55], v[100:103]
    buffer_load_dwordx4 v[112:115], v3, s[8:11], s25 offen offset:2048
    s_add_u32 s25, s25, 3072
    s_waitcnt vmcnt(12) lgkmcnt(0)
    v_mfma_f32_16x16x32_bf16 v[56:59], v[116:119], v[24:27], v[56:59]
    ds_read_b64_tr_b16 v[40:41], v10 offset:28672
    ds_read_b64_tr_b16 v[42:43], v10 offset:30720
    v_mfma_f32_16x16x32_bf16 v[60:63], v[116:119], v[28:31], v[60:63]
    ds_read_b64_tr_b16 v[44:45], v11 offset:28672
    ds_read_b64_tr_b16 v[46:47], v11 offset:30720
    v_mfma_f32_16x16x32_bf16 v[64:67], v[116:119], v[32:35], v[64:67]
    ds_read_b64_tr_b16 v[48:49], v12 offset:28672
    ds_read_b64_tr_b16 v[50:51], v12 offset:30720
    v_mfma_f32_16x16x32_bf16 v[68:71], v[116:119], v[36:39], v[68:71]
    ds_read_b64_tr_b16 v[52:53], v13 offset:28672
    ds_read_b64_tr_b16 v[54:55], v13 offset:30720
    buffer_load_dwordx4 v[116:119], v3, s[8:11], s25 offen offset:0
    v_mfma_f32_16x16x32_bf16 v[72:75], v[120:123], v[24:27], v[72:75]
    v_mfma_f32_16x16x32_bf16 v[76:79], v[120:123], v[28:31], v[76:79]
    v_mfma_f32_16x16x32_bf16 v[80:83], v[120:123], v[32:35], v[80:83]
    v_mfma_f32_16x16x32_bf16 v[84:87], v[120:123], v[36:39], v[84:87]
    buffer_load_dwordx4 v[120:123], v3, s[8:11], s25 offen offset:1024
    v_mfma_f32_16x16x32_bf16 v[88:91], v[124:127], v[24:27], v[88:91]
    v_mfma_f32_16x16x32_bf16 v[92:95], v[124:127], v[28:31], v[92:95]
    v_mfma_f32_16x16x32_bf16 v[96:99], v[124:127], v[32:35], v[96:99]
    v_mfma_f32_16x16x32_bf16 v[100:103], v[124:127], v[36:39], v[100:103]
    buffer_load_dwordx4 v[124:127], v3, s[8:11], s25 offen offset:2048
    s_add_u32 s25, s25, 3072
    s_waitcnt vmcnt(12) lgkmcnt(0)
    v_mfma_f32_16x16x32_bf16 v[56:59], v[128:131], v[40:43], v[56:59]
    ds_read_b64_tr_b16 v[24:25], v10 offset:32768
    ds_read_b64_tr_b16 v[26:27], v10 offset:34816
    v_mfma_f32_16x16x32_bf16 v[60:63], v[128:131], v[44:47], v[60:63]
    ds_read_b64_tr_b16 v[28:29], v11 offset:32768
    ds_read_b64_tr_b16 v[30:31], v11 offset:34816
    v_mfma_f32_16x16x32_bf16 v[64:67], v[128:131], v[48:51], v[64:67]
    ds_read_b64_tr_b16 v[32:33], v12 offset:32768
    ds_read_b64_tr_b16 v[34:35], v12 offset:34816
    v_mfma_f32_16x16x32_bf16 v[68:71], v[128:131], v[52:55], v[68:71]
    ds_read_b64_tr_b16 v[36:37], v13 offset:32768
    ds_read_b64_tr_b16 v[38:39], v13 offset:34816
    buffer_load_dwordx4 v[128:131], v3, s[8:11], s25 offen offset:0
    v_mfma_f32_16x16x32_bf16 v[72:75], v[132:135], v[40:43], v[72:75]
    v_mfma_f32_16x16x32_bf16 v[76:79], v[132:135], v[44:47], v[76:79]
    v_mfma_f32_16x16x32_bf16 v[80:83], v[132:135], v[48:51], v[80:83]
    v_mfma_f32_16x16x32_bf16 v[84:87], v[132:135], v[52:55], v[84:87]
    buffer_load_dwordx4 v[132:135], v3, s[8:11], s25 offen offset:1024
    v_mfma_f32_16x16x32_bf16 v[88:91], v[136:139], v[40:43], v[88:91]
    v_mfma_f32_16x16x32_bf16 v[92:95], v[136:139], v[44:47], v[92:95]
    v_mfma_f32_16x16x32_bf16 v[96:99], v[136:139], v[48:51], v[96:99]
    v_mfma_f32_16x16x32_bf16 v[100:103], v[136:139], v[52:55], v[100:103]
    buffer_load_dwordx4 v[136:139], v3, s[8:11], s25 offen offset:2048
    s_add_u32 s25, s25, 3072
    s_waitcnt vmcnt(12) lgkmcnt(0)
    v_add_u32 v10, 0x9000, v10
    v_add_u32 v11, 0x9000, v11
    v_add_u32 v12, 0x9000, v12
    v_add_u32 v13, 0x9000, v13
    v_mfma_f32_16x16x32_bf16 v[56:59], v[140:143], v[24:27], v[56:59]
    ds_read_b64_tr_b16 v[40:41], v10 offset:0
    ds_read_b64_tr_b16 v[42:43], v10 offset:2048
    v_mfma_f32_16x16x32_bf16 v[60:63], v[140:143], v[28:31], v[60:63]
    ds_read_b64_tr_b16 v[44:45], v11 offset:0
    ds_read_b64_tr_b16 v[46:47], v11 offset:2048
    v_mfma_f32_16x16x32_bf16 v[64:67], v[140:143], v[32:35], v[64:67]
    ds_read_b64_tr_b16 v[48:49], v12 offset:0
    ds_read_b64_tr_b16 v[50:51], v12 offset:2048
    v_mfma_f32_16x16x32_bf16 v[68:71], v[140:143], v[36:39], v[68:71]
    ds_read_b64_tr_b16 v[52:53], v13 offset:0
    ds_read_b64_tr_b16 v[54:55], v13 offset:2048
    buffer_load_dwordx4 v[140:143], v3, s[8:11], s25 offen offset:0
    v_mfma_f32_16x16x32_bf16 v[72:75], v[144:147], v[24:27], v[72:75]
    v_mfma_f32_16x16x32_bf16 v[76:79], v[144:147], v[28:31], v[76:79]
    v_mfma_f32_16x16x32_bf16 v[80:83], v[144:147], v[32:35], v[80:83]
    v_mfma_f32_16x16x32_bf16 v[84:87], v[144:147], v[36:39], v[84:87]
    buffer_load_dwordx4 v[144:147], v3, s[8:11], s25 offen offset:1024
    v_mfma_f32_16x16x32_bf16 v[88:91], v[148:151], v[24:27], v[88:91]
    v_mfma_f32_16x16x32_bf16 v[92:95], v[148:151], v[28:31], v[92:95]
    v_mfma_f32_16x16x32_bf16 v[96:99], v[148:151], v[32:35], v[96:99]
    v_mfma_f32_16x16x32_bf16 v[100:103], v[148:151], v[36:39], v[100:103]
    buffer_load_dwordx4 v[148:151], v3, s[8:11], s25 offen offset:2048
    s_add_u32 s25, s25, 3072
    s_waitcnt vmcnt(12) lgkmcnt(0)
    v_mfma_f32_16x16x32_bf16 v[56:59], v[152:155], v[40:43], v[56:59]
    ds_read_b64_tr_b16 v[24:25], v10 offset:4096
    ds_read_b64_tr_b16 v[26:27], v10 offset:6144
    v_mfma_f32_16x16x32_bf16 v[60:63], v[152:155], v[44:47], v[60:63]
    ds_read_b64_tr_b16 v[28:29], v11 offset:4096
    ds_read_b64_tr_b16 v[30:31], v11 offset:6144
    v_mfma_f32_16x16x32_bf16 v[64:67], v[152:155], v[48:51], v[64:67]
    ds_read_b64_tr_b16 v[32:33], v12 offset:4096
    ds_read_b64_tr_b16 v[34:35], v12 offset:6144
    v_mfma_f32_16x16x32_bf16 v[68:71], v[152:155], v[52:55], v[68:71]
    ds_read_b64_tr_b16 v[36:37], v13 offset:4096
    ds_read_b64_tr_b16 v[38:39], v13 offset:6144
    buffer_load_dwordx4 v[152:155], v3, s[8:11], s25 offen offset:0
    v_mfma_f32_16x16x32_bf16 v[72:75], v[156:159], v[40:43], v[72:75]
    v_mfma_f32_16x16x32_bf16 v[76:79], v[156:159], v[44:47], v[76:79]
    v_mfma_f32_16x16x32_bf16 v[80:83], v[156:159], v[48:51], v[80:83]
    v_mfma_f32_16x16x32_bf16 v[84:87], v[156:159], v[52:55], v[84:87]
    buffer_load_dwordx4 v[156:159], v3, s[8:11], s25 offen offset:1024
    v_mfma_f32_16x16x32_bf16 v[88:91], v[160:163], v[40:43], v[88:91]
    v_mfma_f32_16x16x32_bf16 v[92:95], v[160:163], v[44:47], v[92:95]
    v_mfma_f32_16x16x32_bf16 v[96:99], v[160:163], v[48:51], v[96:99]
    v_mfma_f32_16x16x32_bf16 v[100:103], v[160:163], v[52:55], v[100:103]
    buffer_load_dwordx4 v[160:163], v3, s[8:11], s25 offen offset:2048
    s_add_u32 s25, s25, 3072
    s_waitcnt vmcnt(12) lgkmcnt(0)
    v_mfma_f32_16x16x32_bf16 v[56:59], v[104:107], v[24:27], v[56:59]
    ds_read_b64_tr_b16 v[40:41], v10 offset:8192
    ds_read_b64_tr_b16 v[42:43], v10 offset:10240
    v_mfma_f32_16x16x32_bf16 v[60:63], v[104:107], v[28:31], v[60:63]
    ds_read_b64_tr_b16 v[44:45], v11 offset:8192
    ds_read_b64_tr_b16 v[46:47], v11 offset:10240
    v_mfma_f32_16x16x32_bf16 v[64:67], v[104:107], v[32:35], v[64:67]
    ds_read_b64_tr_b16 v[48:49], v12 offset:8192
    ds_read_b64_tr_b16 v[50:51], v12 offset:10240
    v_mfma_f32_16x16x32_bf16 v[68:71], v[104:107], v[36:39], v[68:71]
    ds_read_b64_tr_b16 v[52:53], v13 offset:8192
    ds_read_b64_tr_b16 v[54:55], v13 offset:10240
    buffer_load_dwordx4 v[104:107], v3, s[8:11], s25 offen offset:0
    v_mfma_f32_16x16x32_bf16 v[72:75], v[108:111], v[24:27], v[72:75]
    v_mfma_f32_16x16x32_bf16 v[76:79], v[108:111], v[28:31], v[76:79]
    v_mfma_f32_16x16x32_bf16 v[80:83], v[108:111], v[32:35], v[80:83]
    v_mfma_f32_16x16x32_bf16 v[84:87], v[108:111], v[36:39], v[84:87]
    buffer_load_dwordx4 v[108:111], v3, s[8:11], s25 offen offset:1024
    v_mfma_f32_16x16x32_bf16 v[88:91], v[112:115], v[24:27], v[88:91]
    v_mfma_f32_16x16x32_bf16 v[92:95], v[112:115], v[28:31], v[92:95]
    v_mfma_f32_16x16x32_bf16 v[96:99], v[112:115], v[32:35], v[96:99]
    v_mfma_f32_16x16x32_bf16 v[100:103], v[112:115], v[36:39], v[100:103]
    buffer_load_dwordx4 v[112:115], v3, s[8:11], s25 offen offset:2048
    s_add_u32 s25, s25, 3072
    s_waitcnt vmcnt(12) lgkmcnt(0)
    v_mfma_f32_16x16x32_bf16 v[56:59], v[116:119], v[40:43], v[56:59]
    ds_read_b64_tr_b16 v[24:25], v10 offset:12288
    ds_read_b64_tr_b16 v[26:27], v10 offset:14336
    v_mfma_f32_16x16x32_bf16 v[60:63], v[116:119], v[44:47], v[60:63]
    ds_read_b64_tr_b16 v[28:29], v11 offset:12288
    ds_read_b64_tr_b16 v[30:31], v11 offset:14336
    v_mfma_f32_16x16x32_bf16 v[64:67], v[116:119], v[48:51], v[64:67]
    ds_read_b64_tr_b16 v[32:33], v12 offset:12288
    ds_read_b64_tr_b16 v[34:35], v12 offset:14336
    v_mfma_f32_16x16x32_bf16 v[68:71], v[116:119], v[52:55], v[68:71]
    ds_read_b64_tr_b16 v[36:37], v13 offset:12288
    ds_read_b64_tr_b16 v[38:39], v13 offset:14336
    buffer_load_dwordx4 v[116:119], v3, s[8:11], s25 offen offset:0
    v_mfma_f32_16x16x32_bf16 v[72:75], v[120:123], v[40:43], v[72:75]
    v_mfma_f32_16x16x32_bf16 v[76:79], v[120:123], v[44:47], v[76:79]
    v_mfma_f32_16x16x32_bf16 v[80:83], v[120:123], v[48:51], v[80:83]
    v_mfma_f32_16x16x32_bf16 v[84:87], v[120:123], v[52:55], v[84:87]
    buffer_load_dwordx4 v[120:123], v3, s[8:11], s25 offen offset:1024
    v_mfma_f32_16x16x32_bf16 v[88:91], v[124:127], v[40:43], v[88:91]
    v_mfma_f32_16x16x32_bf16 v[92:95], v[124:127], v[44:47], v[92:95]
    v_mfma_f32_16x16x32_bf16 v[96:99], v[124:127], v[48:51], v[96:99]
    v_mfma_f32_16x16x32_bf16 v[100:103], v[124:127], v[52:55], v[100:103]
    buffer_load_dwordx4 v[124:127], v3, s[8:11], s25 offen offset:2048
    s_add_u32 s25, s25, 3072
    s_waitcnt vmcnt(12) lgkmcnt(0)
    v_mfma_f32_16x16x32_bf16 v[56:59], v[128:131], v[24:27], v[56:59]
    ds_read_b64_tr_b16 v[40:41], v10 offset:16384
    ds_read_b64_tr_b16 v[42:43], v10 offset:18432
    v_mfma_f32_16x16x32_bf16 v[60:63], v[128:131], v[28:31], v[60:63]
    ds_read_b64_tr_b16 v[44:45], v11 offset:16384
    ds_read_b64_tr_b16 v[46:47], v11 offset:18432
    v_mfma_f32_16x16x32_bf16 v[64:67], v[128:131], v[32:35], v[64:67]
    ds_read_b64_tr_b16 v[48:49], v12 offset:16384
    ds_read_b64_tr_b16 v[50:51], v12 offset:18432
    v_mfma_f32_16x16x32_bf16 v[68:71], v[128:131], v[36:39], v[68:71]
    ds_read_b64_tr_b16 v[52:53], v13 offset:16384
    ds_read_b64_tr_b16 v[54:55], v13 offset:18432
    buffer_load_dwordx4 v[128:131], v3, s[8:11], s25 offen offset:0
    v_mfma_f32_16x16x32_bf16 v[72:75], v[132:135], v[24:27], v[72:75]
    v_mfma_f32_16x16x32_bf16 v[76:79], v[132:135], v[28:31], v[76:79]
    v_mfma_f32_16x16x32_bf16 v[80:83], v[132:135], v[32:35], v[80:83]
    v_mfma_f32_16x16x32_bf16 v[84:87], v[132:135], v[36:39], v[84:87]
    buffer_load_dwordx4 v[132:135], v3, s[8:11], s25 offen offset:1024
    v_mfma_f32_16x16x32_bf16 v[88:91], v[136:139], v[24:27], v[88:91]
    v_mfma_f32_16x16x32_bf16 v[92:95], v[136:139], v[28:31], v[92:95]
    v_mfma_f32_16x16x32_bf16 v[96:99], v[136:139], v[32:35], v[96:99]
    v_mfma_f32_16x16x32_bf16 v[100:103], v[136:139], v[36:39], v[100:103]
    buffer_load_dwordx4 v[136:139], v3, s[8:11], s25 offen offset:2048
    s_add_u32 s25, s25, 3072
    s_waitcnt vmcnt(12) lgkmcnt(0)
    v_mfma_f32_16x16x32_bf16 v[56:59], v[140:143], v[40:43], v[56:59]
    ds_read_b64_tr_b16 v[24:25], v10 offset:20480
    ds_read_b64_tr_b16 v[26:27], v10 offset:22528
    v_mfma_f32_16x16x32_bf16 v[60:63], v[140:143], v[44:47], v[60:63]
    ds_read_b64_tr_b16 v[28:29], v11 offset:20480
    ds_read_b64_tr_b16 v[30:31], v11 offset:22528
    v_mfma_f32_16x16x32_bf16 v[64:67], v[140:143], v[48:51], v[64:67]
    ds_read_b64_tr_b16 v[32:33], v12 offset:20480
    ds_read_b64_tr_b16 v[34:35], v12 offset:22528
    v_mfma_f32_16x16x32_bf16 v[68:71], v[140:143], v[52:55], v[68:71]
    ds_read_b64_tr_b16 v[36:37], v13 offset:20480
    ds_read_b64_tr_b16 v[38:39], v13 offset:22528
    buffer_load_dwordx4 v[140:143], v3, s[8:11], s26 offen offset:0
    v_mfma_f32_16x16x32_bf16 v[72:75], v[144:147], v[40:43], v[72:75]
    v_mfma_f32_16x16x32_bf16 v[76:79], v[144:147], v[44:47], v[76:79]
    v_mfma_f32_16x16x32_bf16 v[80:83], v[144:147], v[48:51], v[80:83]
    v_mfma_f32_16x16x32_bf16 v[84:87], v[144:147], v[52:55], v[84:87]
    buffer_load_dwordx4 v[144:147], v3, s[8:11], s26 offen offset:1024
    v_mfma_f32_16x16x32_bf16 v[88:91], v[148:151], v[40:43], v[88:91]
    v_mfma_f32_16x16x32_bf16 v[92:95], v[148:151], v[44:47], v[92:95]
    v_mfma_f32_16x16x32_bf16 v[96:99], v[148:151], v[48:51], v[96:99]
    v_mfma_f32_16x16x32_bf16 v[100:103], v[148:151], v[52:55], v[100:103]
    buffer_load_dwordx4 v[148:151], v3, s[8:11], s26 offen offset:2048
    s_add_u32 s26, s26, 3072
    s_waitcnt vmcnt(12) lgkmcnt(0)
    v_mfma_f32_16x16x32_bf16 v[56:59], v[152:155], v[24:27], v[56:59]
    ds_read_b64_tr_b16 v[40:41], v10 offset:24576
    ds_read_b64_tr_b16 v[42:43], v10 offset:26624
    v_mfma_f32_16x16x32_bf16 v[60:63], v[152:155], v[28:31], v[60:63]
    ds_read_b64_tr_b16 v[44:45], v11 offset:24576
    ds_read_b64_tr_b16 v[46:47], v11 offset:26624
    v_mfma_f32_16x16x32_bf16 v[64:67], v[152:155], v[32:35], v[64:67]
    ds_read_b64_tr_b16 v[48:49], v12 offset:24576
    ds_read_b64_tr_b16 v[50:51], v12 offset:26624
    v_mfma_f32_16x16x32_bf16 v[68:71], v[152:155], v[36:39], v[68:71]
    ds_read_b64_tr_b16 v[52:53], v13 offset:24576
    ds_read_b64_tr_b16 v[54:55], v13 offset:26624
    buffer_load_dwordx4 v[152:155], v3, s[8:11], s26 offen offset:0
    v_mfma_f32_16x16x32_bf16 v[72:75], v[156:159], v[24:27], v[72:75]
    v_mfma_f32_16x16x32_bf16 v[76:79], v[156:159], v[28:31], v[76:79]
    v_mfma_f32_16x16x32_bf16 v[80:83], v[156:159], v[32:35], v[80:83]
    v_mfma_f32_16x16x32_bf16 v[84:87], v[156:159], v[36:39], v[84:87]
    buffer_load_dwordx4 v[156:159], v3, s[8:11], s26 offen offset:1024
    v_mfma_f32_16x16x32_bf16 v[88:91], v[160:163], v[24:27], v[88:91]
    v_mfma_f32_16x16x32_bf16 v[92:95], v[160:163], v[28:31], v[92:95]
    v_mfma_f32_16x16x32_bf16 v[96:99], v[160:163], v[32:35], v[96:99]
    v_mfma_f32_16x16x32_bf16 v[100:103], v[160:163], v[36:39], v[100:103]
    buffer_load_dwordx4 v[160:163], v3, s[8:11], s26 offen offset:2048
    s_add_u32 s26, s26, 3072
    s_waitcnt vmcnt(12) lgkmcnt(0)
    v_mfma_f32_16x16x32_bf16 v[56:59], v[104:107], v[40:43], v[56:59]
    ds_read_b64_tr_b16 v[24:25], v10 offset:28672
    ds_read_b64_tr_b16 v[26:27], v10 offset:30720
    v_mfma_f32_16x16x32_bf16 v[60:63], v[104:107], v[44:47], v[60:63]
    ds_read_b64_tr_b16 v[28:29], v11 offset:28672
    ds_read_b64_tr_b16 v[30:31], v11 offset:30720
    v_mfma_f32_16x16x32_bf16 v[64:67], v[104:107], v[48:51], v[64:67]
    ds_read_b64_tr_b16 v[32:33], v12 offset:28672
    ds_read_b64_tr_b16 v[34:35], v12 offset:30720
    v_mfma_f32_16x16x32_bf16 v[68:71], v[104:107], v[52:55], v[68:71]
    ds_read_b64_tr_b16 v[36:37], v13 offset:28672
    ds_read_b64_tr_b16 v[38:39], v13 offset:30720
    buffer_load_dwordx4 v[104:107], v3, s[8:11], s26 offen offset:0
    v_mfma_f32_16x16x32_bf16 v[72:75], v[108:111], v[40:43], v[72:75]
    v_mfma_f32_16x16x32_bf16 v[76:79], v[108:111], v[44:47], v[76:79]
    v_mfma_f32_16x16x32_bf16 v[80:83], v[108:111], v[48:51], v[80:83]
    v_mfma_f32_16x16x32_bf16 v[84:87], v[108:111], v[52:55], v[84:87]
    buffer_load_dwordx4 v[108:111], v3, s[8:11], s26 offen offset:1024
    v_mfma_f32_16x16x32_bf16 v[88:91], v[112:115], v[40:43], v[88:91]
    v_mfma_f32_16x16x32_bf16 v[92:95], v[112:115], v[44:47], v[92:95]
    v_mfma_f32_16x16x32_bf16 v[96:99], v[112:115], v[48:51], v[96:99]
    v_mfma_f32_16x16x32_bf16 v[100:103], v[112:115], v[52:55], v[100:103]
    buffer_load_dwordx4 v[112:115], v3, s[8:11], s26 offen offset:2048
    s_add_u32 s26, s26, 3072
    s_waitcnt vmcnt(12) lgkmcnt(0)
    v_mfma_f32_16x16x32_bf16 v[56:59], v[116:119], v[24:27], v[56:59]
    ds_read_b64_tr_b16 v[40:41], v10 offset:32768
    ds_read_b64_tr_b16 v[42:43], v10 offset:34816
    v_mfma_f32_16x16x32_bf16 v[60:63], v[116:119], v[28:31], v[60:63]
    ds_read_b64_tr_b16 v[44:45], v11 offset:32768
    ds_read_b64_tr_b16 v[46:47], v11 offset:34816
    v_mfma_f32_16x16x32_bf16 v[64:67], v[116:119], v[32:35], v[64:67]
    ds_read_b64_tr_b16 v[48:49], v12 offset:32768
    ds_read_b64_tr_b16 v[50:51], v12 offset:34816
    v_mfma_f32_16x16x32_bf16 v[68:71], v[116:119], v[36:39], v[68:71]
    ds_read_b64_tr_b16 v[52:53], v13 offset:32768
    ds_read_b64_tr_b16 v[54:55], v13 offset:34816
    buffer_load_dwordx4 v[116:119], v3, s[8:11], s26 offen offset:0
    v_mfma_f32_16x16x32_bf16 v[72:75], v[120:123], v[24:27], v[72:75]
    v_mfma_f32_16x16x32_bf16 v[76:79], v[120:123], v[28:31], v[76:79]
    v_mfma_f32_16x16x32_bf16 v[80:83], v[120:123], v[32:35], v[80:83]
    v_mfma_f32_16x16x32_bf16 v[84:87], v[120:123], v[36:39], v[84:87]
    buffer_load_dwordx4 v[120:123], v3, s[8:11], s26 offen offset:1024
    v_mfma_f32_16x16x32_bf16 v[88:91], v[124:127], v[24:27], v[88:91]
    v_mfma_f32_16x16x32_bf16 v[92:95], v[124:127], v[28:31], v[92:95]
    v_mfma_f32_16x16x32_bf16 v[96:99], v[124:127], v[32:35], v[96:99]
    v_mfma_f32_16x16x32_bf16 v[100:103], v[124:127], v[36:39], v[100:103]
    buffer_load_dwordx4 v[124:127], v3, s[8:11], s26 offen offset:2048
    s_add_u32 s26, s26, 3072
    s_waitcnt vmcnt(12) lgkmcnt(0)
    v_mfma_f32_16x16x32_bf16 v[56:59], v[128:131], v[40:43], v[56:59]
    v_mfma_f32_16x16x32_bf16 v[60:63], v[128:131], v[44:47], v[60:63]
    v_mfma_f32_16x16x32_bf16 v[64:67], v[128:131], v[48:51], v[64:67]
    v_mfma_f32_16x16x32_bf16 v[68:71], v[128:131], v[52:55], v[68:71]
    buffer_load_dwordx4 v[128:131], v3, s[8:11], s26 offen offset:0
    v_mfma_f32_16x16x32_bf16 v[72:75], v[132:135], v[40:43], v[72:75]
    v_mfma_f32_16x16x32_bf16 v[76:79], v[132:135], v[44:47], v[76:79]
    v_mfma_f32_16x16x32_bf16 v[80:83], v[132:135], v[48:51], v[80:83]
    v_mfma_f32_16x16x32_bf16 v[84:87], v[132:135], v[52:55], v[84:87]
    buffer_load_dwordx4 v[132:135], v3, s[8:11], s26 offen offset:1024
    v_mfma_f32_16x16x32_bf16 v[88:91], v[136:139], v[40:43], v[88:91]
    v_mfma_f32_16x16x32_bf16 v[92:95], v[136:139], v[44:47], v[92:95]
    v_mfma_f32_16x16x32_bf16 v[96:99], v[136:139], v[48:51], v[96:99]
    v_mfma_f32_16x16x32_bf16 v[100:103], v[136:139], v[52:55], v[100:103]
    buffer_load_dwordx4 v[136:139], v3, s[8:11], s26 offen offset:2048
    s_add_u32 s26, s26, 3072
    v_mov_b32 v18, 154176
KF_SW:
    ds_read_b128 v[24:27], v18
    ds_read_b128 v[28:31], v18 offset:16
    ds_read_b128 v[32:35], v18 offset:32
    s_waitcnt lgkmcnt(0)
    v_and_b32 v24, v24, v25
    v_and_b32 v24, v24, v26
    v_and_b32 v24, v24, v27
    v_and_b32 v24, v24, v28
    v_and_b32 v24, v24, v29
    v_and_b32 v24, v24, v30
    v_and_b32 v24, v24, v31
    v_and_b32 v24, v24, v32
    v_and_b32 v24, v24, v33
    v_and_b32 v24, v24, v34
    v_and_b32 v24, v24, v35
    s_nop 0
    v_readfirstlane_b32 s30, v24
    s_nop 0
    s_cmp_eq_u32 s30, 1
    s_cbranch_scc0 KF_SW
    ds_read_b64 v[24:25], v6 offset:0
    ds_read_b64 v[26:27], v6 offset:128
    ds_read_b64 v[28:29], v6 offset:256
    ds_read_b64 v[30:31], v6 offset:384
    ds_read_b64 v[32:33], v6 offset:512
    ds_read_b64 v[34:35], v6 offset:640
    ds_read_b64 v[36:37], v6 offset:768
    ds_read_b64 v[38:39], v6 offset:896
    ds_read_b64 v[40:41], v6 offset:1024
    ds_read_b64 v[42:43], v6 offset:1152
    ds_read_b64 v[44:45], v6 offset:1280
    ds_read_b64 v[46:47], v6 offset:1408
    s_waitcnt lgkmcnt(0)
    v_pk_add_f32 v[24:25], v[24:25], v[32:33]
    v_pk_add_f32 v[24:25], v[24:25], v[40:41]
    v_mul_f32 v10, 0x3ae38e39, v24
    v_mul_f32 v11, 0x3ae38e39, v25
    v_fma_f32 v11, -v10, v10, v11
    v_max_f32 v11, 0, v11
    v_cvt_pk_bf16_f32 v10, v10, v11
    v_and_b32 v11, 0xffff0000, v10
    v_lshlrev_b32 v10, 16, v10
    v_sub_f32 v10, 0, v10
    v_add_f32 v11, 0x3727c5ac, v11
    v_cvt_pk_bf16_f32 v11, v11, v11
    v_lshlrev_b32 v11, 16, v11
    v_sqrt_f32 v11, v11
    s_nop 0
    v_cvt_pk_bf16_f32 v11, v11, v11
    v_lshlrev_b32 v11, 16, v11
    v_rcp_f32 v11, v11
    s_nop 0
    v_mul_f32 v11, 0xbfb8aa3b, v11
    v_pk_add_f32 v[26:27], v[26:27], v[34:35]
    v_pk_add_f32 v[26:27], v[26:27], v[42:43]
    v_mul_f32 v12, 0x3ae38e39, v26
    v_mul_f32 v13, 0x3ae38e39, v27
    v_fma_f32 v13, -v12, v12, v13
    v_max_f32 v13, 0, v13
    v_cvt_pk_bf16_f32 v12, v12, v13
    v_and_b32 v13, 0xffff0000, v12
    v_lshlrev_b32 v12, 16, v12
    v_sub_f32 v12, 0, v12
    v_add_f32 v13, 0x3727c5ac, v13
    v_cvt_pk_bf16_f32 v13, v13, v13
    v_lshlrev_b32 v13, 16, v13
    v_sqrt_f32 v13, v13
    s_nop 0
    v_cvt_pk_bf16_f32 v13, v13, v13
    v_lshlrev_b32 v13, 16, v13
    v_rcp_f32 v13, v13
    s_nop 0
    v_mul_f32 v13, 0xbfb8aa3b, v13
    v_pk_add_f32 v[28:29], v[28:29], v[36:37]
    v_pk_add_f32 v[28:29], v[28:29], v[44:45]
    v_mul_f32 v14, 0x3ae38e39, v28
    v_mul_f32 v15, 0x3ae38e39, v29
    v_fma_f32 v15, -v14, v14, v15
    v_max_f32 v15, 0, v15
    v_cvt_pk_bf16_f32 v14, v14, v15
    v_and_b32 v15, 0xffff0000, v14
    v_lshlrev_b32 v14, 16, v14
    v_sub_f32 v14, 0, v14
    v_add_f32 v15, 0x3727c5ac, v15
    v_cvt_pk_bf16_f32 v15, v15, v15
    v_lshlrev_b32 v15, 16, v15
    v_sqrt_f32 v15, v15
    s_nop 0
    v_cvt_pk_bf16_f32 v15, v15, v15
    v_lshlrev_b32 v15, 16, v15
    v_rcp_f32 v15, v15
    s_nop 0
    v_mul_f32 v15, 0xbfb8aa3b, v15
    v_pk_add_f32 v[30:31], v[30:31], v[38:39]
    v_pk_add_f32 v[30:31], v[30:31], v[46:47]
    v_mul_f32 v16, 0x3ae38e39, v30
    v_mul_f32 v17, 0x3ae38e39, v31
    v_fma_f32 v17, -v16, v16, v17
    v_max_f32 v17, 0, v17
    v_cvt_pk_bf16_f32 v16, v16, v17
    v_and_b32 v17, 0xffff0000, v16
    v_lshlrev_b32 v16, 16, v16
    v_sub_f32 v16, 0, v16
    v_add_f32 v17, 0x3727c5ac, v17
    v_cvt_pk_bf16_f32 v17, v17, v17
    v_lshlrev_b32 v17, 16, v17
    v_sqrt_f32 v17, v17
    s_nop 0
    v_cvt_pk_bf16_f32 v17, v17, v17
    v_lshlrev_b32 v17, 16, v17
    v_rcp_f32 v17, v17
    s_nop 0
    v_mul_f32 v17, 0xbfb8aa3b, v17
    ds_read_b128 v[24:27], v22 offset:0
    ds_read_b128 v[28:31], v22 offset:2304
    ds_read_b128 v[32:35], v22 offset:64
    ds_read_b128 v[36:39], v22 offset:2368
    ds_read_b128 v[40:43], v22 offset:128
    ds_read_b128 v[44:47], v22 offset:2432
    s_waitcnt lgkmcnt(0)
    v_fmac_f32 v56, v24, v10
    v_fmac_f32 v57, v25, v10
    v_fmac_f32 v58, v26, v10
    v_fmac_f32 v59, v27, v10
    v_fmac_f32 v60, v24, v12
    v_fmac_f32 v61, v25, v12
    v_fmac_f32 v62, v26, v12
    v_fmac_f32 v63, v27, v12
    v_fma_f32 v56, v56, v11, v28
    v_fma_f32 v57, v57, v11, v29
    v_fma_f32 v58, v58, v11, v30
    v_fma_f32 v59, v59, v11, v31
    v_fma_f32 v60, v60, v13, v28
    v_fma_f32 v61, v61, v13, v29
    v_fma_f32 v62, v62, v13, v30
    v_fma_f32 v63, v63, v13, v31
    v_exp_f32 v48, v56
    v_exp_f32 v49, v57
    v_exp_f32 v50, v58
    v_exp_f32 v51, v59
    v_exp_f32 v52, v60
    v_exp_f32 v53, v61
    v_exp_f32 v54, v62
    v_exp_f32 v55, v63
    v_add_f32 v48, 1.0, v48
    v_add_f32 v49, 1.0, v49
    v_add_f32 v50, 1.0, v50
    v_add_f32 v51, 1.0, v51
    v_add_f32 v52, 1.0, v52
    v_add_f32 v53, 1.0, v53
    v_add_f32 v54, 1.0, v54
    v_add_f32 v55, 1.0, v55
    v_rcp_f32 v48, v48
    v_rcp_f32 v49, v49
    v_rcp_f32 v50, v50
    v_rcp_f32 v51, v51
    v_rcp_f32 v52, v52
    v_rcp_f32 v53, v53
    v_rcp_f32 v54, v54
    v_rcp_f32 v55, v55
    v_mul_f32 v56, v56, v48
    v_mul_f32 v57, v57, v49
    v_mul_f32 v58, v58, v50
    v_mul_f32 v59, v59, v51
    v_mul_f32 v60, v60, v52
    v_mul_f32 v61, v61, v53
    v_mul_f32 v62, v62, v54
    v_mul_f32 v63, v63, v55
    v_cvt_pk_bf16_f32 v56, v56, v57
    v_cvt_pk_bf16_f32 v57, v58, v59
    v_cvt_pk_bf16_f32 v60, v60, v61
    v_cvt_pk_bf16_f32 v61, v62, v63
    ds_write_b64 v19, v[56:57] offset:0
    ds_write_b64 v19, v[60:61] offset:1024
    v_fmac_f32 v64, v24, v14
    v_fmac_f32 v65, v25, v14
    v_fmac_f32 v66, v26, v14
    v_fmac_f32 v67, v27, v14
    v_fmac_f32 v68, v24, v16
    v_fmac_f32 v69, v25, v16
    v_fmac_f32 v70, v26, v16
    v_fmac_f32 v71, v27, v16
    v_fma_f32 v64, v64, v15, v28
    v_fma_f32 v65, v65, v15, v29
    v_fma_f32 v66, v66, v15, v30
    v_fma_f32 v67, v67, v15, v31
    v_fma_f32 v68, v68, v17, v28
    v_fma_f32 v69, v69, v17, v29
    v_fma_f32 v70, v70, v17, v30
    v_fma_f32 v71, v71, v17, v31
    v_exp_f32 v48, v64
    v_exp_f32 v49, v65
    v_exp_f32 v50, v66
    v_exp_f32 v51, v67
    v_exp_f32 v52, v68
    v_exp_f32 v53, v69
    v_exp_f32 v54, v70
    v_exp_f32 v55, v71
    v_add_f32 v48, 1.0, v48
    v_add_f32 v49, 1.0, v49
    v_add_f32 v50, 1.0, v50
    v_add_f32 v51, 1.0, v51
    v_add_f32 v52, 1.0, v52
    v_add_f32 v53, 1.0, v53
    v_add_f32 v54, 1.0, v54
    v_add_f32 v55, 1.0, v55
    v_rcp_f32 v48, v48
    v_rcp_f32 v49, v49
    v_rcp_f32 v50, v50
    v_rcp_f32 v51, v51
    v_rcp_f32 v52, v52
    v_rcp_f32 v53, v53
    v_rcp_f32 v54, v54
    v_rcp_f32 v55, v55
    v_mul_f32 v64, v64, v48
    v_mul_f32 v65, v65, v49
    v_mul_f32 v66, v66, v50
    v_mul_f32 v67, v67, v51
    v_mul_f32 v68, v68, v52
    v_mul_f32 v69, v69, v53
    v_mul_f32 v70, v70, v54
    v_mul_f32 v71, v71, v55
    v_cvt_pk_bf16_f32 v64, v64, v65
    v_cvt_pk_bf16_f32 v65, v66, v67
    v_cvt_pk_bf16_f32 v68, v68, v69
    v_cvt_pk_bf16_f32 v69, v70, v71
    ds_write_b64 v19, v[64:65] offset:2048
    ds_write_b64 v19, v[68:69] offset:3072
    v_fmac_f32 v72, v32, v10
    v_fmac_f32 v73, v33, v10
    v_fmac_f32 v74, v34, v10
    v_fmac_f32 v75, v35, v10
    v_fmac_f32 v76, v32, v12
    v_fmac_f32 v77, v33, v12
    v_fmac_f32 v78, v34, v12
    v_fmac_f32 v79, v35, v12
    v_fma_f32 v72, v72, v11, v36
    v_fma_f32 v73, v73, v11, v37
    v_fma_f32 v74, v74, v11, v38
    v_fma_f32 v75, v75, v11, v39
    v_fma_f32 v76, v76, v13, v36
    v_fma_f32 v77, v77, v13, v37
    v_fma_f32 v78, v78, v13, v38
    v_fma_f32 v79, v79, v13, v39
    v_exp_f32 v48, v72
    v_exp_f32 v49, v73
    v_exp_f32 v50, v74
    v_exp_f32 v51, v75
    v_exp_f32 v52, v76
    v_exp_f32 v53, v77
    v_exp_f32 v54, v78
    v_exp_f32 v55, v79
    v_add_f32 v48, 1.0, v48
    v_add_f32 v49, 1.0, v49
    v_add_f32 v50, 1.0, v50
    v_add_f32 v51, 1.0, v51
    v_add_f32 v52, 1.0, v52
    v_add_f32 v53, 1.0, v53
    v_add_f32 v54, 1.0, v54
    v_add_f32 v55, 1.0, v55
    v_rcp_f32 v48, v48
    v_rcp_f32 v49, v49
    v_rcp_f32 v50, v50
    v_rcp_f32 v51, v51
    v_rcp_f32 v52, v52
    v_rcp_f32 v53, v53
    v_rcp_f32 v54, v54
    v_rcp_f32 v55, v55
    v_mul_f32 v72, v72, v48
    v_mul_f32 v73, v73, v49
    v_mul_f32 v74, v74, v50
    v_mul_f32 v75, v75, v51
    v_mul_f32 v76, v76, v52
    v_mul_f32 v77, v77, v53
    v_mul_f32 v78, v78, v54
    v_mul_f32 v79, v79, v55
    v_cvt_pk_bf16_f32 v72, v72, v73
    v_cvt_pk_bf16_f32 v73, v74, v75
    v_cvt_pk_bf16_f32 v76, v76, v77
    v_cvt_pk_bf16_f32 v77, v78, v79
    ds_write_b64 v20, v[72:73] offset:0
    ds_write_b64 v20, v[76:77] offset:1024
    v_fmac_f32 v80, v32, v14
    v_fmac_f32 v81, v33, v14
    v_fmac_f32 v82, v34, v14
    v_fmac_f32 v83, v35, v14
    v_fmac_f32 v84, v32, v16
    v_fmac_f32 v85, v33, v16
    v_fmac_f32 v86, v34, v16
    v_fmac_f32 v87, v35, v16
    v_fma_f32 v80, v80, v15, v36
    v_fma_f32 v81, v81, v15, v37
    v_fma_f32 v82, v82, v15, v38
    v_fma_f32 v83, v83, v15, v39
    v_fma_f32 v84, v84, v17, v36
    v_fma_f32 v85, v85, v17, v37
    v_fma_f32 v86, v86, v17, v38
    v_fma_f32 v87, v87, v17, v39
    v_exp_f32 v48, v80
    v_exp_f32 v49, v81
    v_exp_f32 v50, v82
    v_exp_f32 v51, v83
    v_exp_f32 v52, v84
    v_exp_f32 v53, v85
    v_exp_f32 v54, v86
    v_exp_f32 v55, v87
    v_add_f32 v48, 1.0, v48
    v_add_f32 v49, 1.0, v49
    v_add_f32 v50, 1.0, v50
    v_add_f32 v51, 1.0, v51
    v_add_f32 v52, 1.0, v52
    v_add_f32 v53, 1.0, v53
    v_add_f32 v54, 1.0, v54
    v_add_f32 v55, 1.0, v55
    v_rcp_f32 v48, v48
    v_rcp_f32 v49, v49
    v_rcp_f32 v50, v50
    v_rcp_f32 v51, v51
    v_rcp_f32 v52, v52
    v_rcp_f32 v53, v53
    v_rcp_f32 v54, v54
    v_rcp_f32 v55, v55
    v_mul_f32 v80, v80, v48
    v_mul_f32 v81, v81, v49
    v_mul_f32 v82, v82, v50
    v_mul_f32 v83, v83, v51
    v_mul_f32 v84, v84, v52
    v_mul_f32 v85, v85, v53
    v_mul_f32 v86, v86, v54
    v_mul_f32 v87, v87, v55
    v_cvt_pk_bf16_f32 v80, v80, v81
    v_cvt_pk_bf16_f32 v81, v82, v83
    v_cvt_pk_bf16_f32 v84, v84, v85
    v_cvt_pk_bf16_f32 v85, v86, v87
    ds_write_b64 v20, v[80:81] offset:2048
    ds_write_b64 v20, v[84:85] offset:3072
    v_fmac_f32 v88, v40, v10
    v_fmac_f32 v89, v41, v10
    v_fmac_f32 v90, v42, v10
    v_fmac_f32 v91, v43, v10
    v_fmac_f32 v92, v40, v12
    v_fmac_f32 v93, v41, v12
    v_fmac_f32 v94, v42, v12
    v_fmac_f32 v95, v43, v12
    v_fma_f32 v88, v88, v11, v44
    v_fma_f32 v89, v89, v11, v45
    v_fma_f32 v90, v90, v11, v46
    v_fma_f32 v91, v91, v11, v47
    v_fma_f32 v92, v92, v13, v44
    v_fma_f32 v93, v93, v13, v45
    v_fma_f32 v94, v94, v13, v46
    v_fma_f32 v95, v95, v13, v47
    v_exp_f32 v48, v88
    v_exp_f32 v49, v89
    v_exp_f32 v50, v90
    v_exp_f32 v51, v91
    v_exp_f32 v52, v92
    v_exp_f32 v53, v93
    v_exp_f32 v54, v94
    v_exp_f32 v55, v95
    v_add_f32 v48, 1.0, v48
    v_add_f32 v49, 1.0, v49
    v_add_f32 v50, 1.0, v50
    v_add_f32 v51, 1.0, v51
    v_add_f32 v52, 1.0, v52
    v_add_f32 v53, 1.0, v53
    v_add_f32 v54, 1.0, v54
    v_add_f32 v55, 1.0, v55
    v_rcp_f32 v48, v48
    v_rcp_f32 v49, v49
    v_rcp_f32 v50, v50
    v_rcp_f32 v51, v51
    v_rcp_f32 v52, v52
    v_rcp_f32 v53, v53
    v_rcp_f32 v54, v54
    v_rcp_f32 v55, v55
    v_mul_f32 v88, v88, v48
    v_mul_f32 v89, v89, v49
    v_mul_f32 v90, v90, v50
    v_mul_f32 v91, v91, v51
    v_mul_f32 v92, v92, v52
    v_mul_f32 v93, v93, v53
    v_mul_f32 v94, v94, v54
    v_mul_f32 v95, v95, v55
    v_cvt_pk_bf16_f32 v88, v88, v89
    v_cvt_pk_bf16_f32 v89, v90, v91
    v_cvt_pk_bf16_f32 v92, v92, v93
    v_cvt_pk_bf16_f32 v93, v94, v95
    ds_write_b64 v21, v[88:89] offset:0
    ds_write_b64 v21, v[92:93] offset:1024
    v_fmac_f32 v96, v40, v14
    v_fmac_f32 v97, v41, v14
    v_fmac_f32 v98, v42, v14
    v_fmac_f32 v99, v43, v14
    v_fmac_f32 v100, v40, v16
    v_fmac_f32 v101, v41, v16
    v_fmac_f32 v102, v42, v16
    v_fmac_f32 v103, v43, v16
    v_fma_f32 v96, v96, v15, v44
    v_fma_f32 v97, v97, v15, v45
    v_fma_f32 v98, v98, v15, v46
    v_fma_f32 v99, v99, v15, v47
    v_fma_f32 v100, v100, v17, v44
    v_fma_f32 v101, v101, v17, v45
    v_fma_f32 v102, v102, v17, v46
    v_fma_f32 v103, v103, v17, v47
    v_exp_f32 v48, v96
    v_exp_f32 v49, v97
    v_exp_f32 v50, v98
    v_exp_f32 v51, v99
    v_exp_f32 v52, v100
    v_exp_f32 v53, v101
    v_exp_f32 v54, v102
    v_exp_f32 v55, v103
    v_add_f32 v48, 1.0, v48
    v_add_f32 v49, 1.0, v49
    v_add_f32 v50, 1.0, v50
    v_add_f32 v51, 1.0, v51
    v_add_f32 v52, 1.0, v52
    v_add_f32 v53, 1.0, v53
    v_add_f32 v54, 1.0, v54
    v_add_f32 v55, 1.0, v55
    v_rcp_f32 v48, v48
    v_rcp_f32 v49, v49
    v_rcp_f32 v50, v50
    v_rcp_f32 v51, v51
    v_rcp_f32 v52, v52
    v_rcp_f32 v53, v53
    v_rcp_f32 v54, v54
    v_rcp_f32 v55, v55
    v_mul_f32 v96, v96, v48
    v_mul_f32 v97, v97, v49
    v_mul_f32 v98, v98, v50
    v_mul_f32 v99, v99, v51
    v_mul_f32 v100, v100, v52
    v_mul_f32 v101, v101, v53
    v_mul_f32 v102, v102, v54
    v_mul_f32 v103, v103, v55
    v_cvt_pk_bf16_f32 v96, v96, v97
    v_cvt_pk_bf16_f32 v97, v98, v99
    v_cvt_pk_bf16_f32 v100, v100, v101
    v_cvt_pk_bf16_f32 v101, v102, v103
    ds_write_b64 v21, v[96:97] offset:2048
    ds_write_b64 v21, v[100:101] offset:3072
    s_waitcnt lgkmcnt(0)
    v_mov_b32 v9, 1
    ds_write_b32 v5, v9
    v_mov_b32 v5, 154112
KF_W0:
    ds_read_b64 v[18:19], v5 offset:0
    s_waitcnt lgkmcnt(0)
    v_and_b32 v18, v18, v19
    s_nop 0
    v_readfirstlane_b32 s30, v18
    s_nop 0
    s_cmp_eq_u32 s30, 1
    s_cbranch_scc1 KF_G0
    s_branch KF_W0
KF_G0:
    ds_read_b128 v[24:27], v4 offset:0
    ds_read_b128 v[28:31], v4 offset:1024
    ds_read_b128 v[32:35], v4 offset:2048
    ds_read_b128 v[36:39], v4 offset:3072
    s_waitcnt vmcnt(12) lgkmcnt(0)
    v_mfma_f32_16x16x32_bf16 v[56:59], v[140:143], v[24:27], 0
    ds_read_b128 v[40:43], v4 offset:4096
    ds_read_b128 v[44:47], v4 offset:5120
    v_mfma_f32_16x16x32_bf16 v[60:63], v[140:143], v[28:31], 0
    ds_read_b128 v[48:51], v4 offset:6144
    ds_read_b128 v[52:55], v4 offset:7168
    v_mfma_f32_16x16x32_bf16 v[64:67], v[140:143], v[32:35], 0
    v_mfma_f32_16x16x32_bf16 v[68:71], v[140:143], v[36:39], 0
    buffer_load_dwordx4 v[140:143], v3, s[8:11], s26 offen offset:0
    v_mfma_f32_16x16x32_bf16 v[72:75], v[144:147], v[24:27], 0
    v_mfma_f32_16x16x32_bf16 v[76:79], v[144:147], v[28:31], 0
    v_mfma_f32_16x16x32_bf16 v[80:83], v[144:147], v[32:35], 0
    v_mfma_f32_16x16x32_bf16 v[84:87], v[144:147], v[36:39], 0
    buffer_load_dwordx4 v[144:147], v3, s[8:11], s26 offen offset:1024
    v_mfma_f32_16x16x32_bf16 v[88:91], v[148:151], v[24:27], 0
    v_mfma_f32_16x16x32_bf16 v[92:95], v[148:151], v[28:31], 0
    v_mfma_f32_16x16x32_bf16 v[96:99], v[148:151], v[32:35], 0
    v_mfma_f32_16x16x32_bf16 v[100:103], v[148:151], v[36:39], 0
    buffer_load_dwordx4 v[148:151], v3, s[8:11], s26 offen offset:2048
    s_add_u32 s26, s26, 3072
    s_waitcnt vmcnt(12) lgkmcnt(0)
    v_mfma_f32_16x16x32_bf16 v[56:59], v[152:155], v[40:43], v[56:59]
    ds_read_b128 v[24:27], v4 offset:8192
    ds_read_b128 v[28:31], v4 offset:9216
    v_mfma_f32_16x16x32_bf16 v[60:63], v[152:155], v[44:47], v[60:63]
    ds_read_b128 v[32:35], v4 offset:10240
    ds_read_b128 v[36:39], v4 offset:11264
    v_mfma_f32_16x16x32_bf16 v[64:67], v[152:155], v[48:51], v[64:67]
    v_mfma_f32_16x16x32_bf16 v[68:71], v[152:155], v[52:55], v[68:71]
    buffer_load_dwordx4 v[152:155], v3, s[8:11], s26 offen offset:0
    v_mfma_f32_16x16x32_bf16 v[72:75], v[156:159], v[40:43], v[72:75]
    v_mfma_f32_16x16x32_bf16 v[76:79], v[156:159], v[44:47], v[76:79]
    v_mfma_f32_16x16x32_bf16 v[80:83], v[156:159], v[48:51], v[80:83]
    v_mfma_f32_16x16x32_bf16 v[84:87], v[156:159], v[52:55], v[84:87]
    buffer_load_dwordx4 v[156:159], v3, s[8:11], s26 offen offset:1024
    v_mfma_f32_16x16x32_bf16 v[88:91], v[160:163], v[40:43], v[88:91]
    v_mfma_f32_16x16x32_bf16 v[92:95], v[160:163], v[44:47], v[92:95]
    v_mfma_f32_16x16x32_bf16 v[96:99], v[160:163], v[48:51], v[96:99]
    v_mfma_f32_16x16x32_bf16 v[100:103], v[160:163], v[52:55], v[100:103]
    buffer_load_dwordx4 v[160:163], v3, s[8:11], s26 offen offset:2048
    s_add_u32 s26, s26, 3072
    s_waitcnt vmcnt(12) lgkmcnt(0)
KF_W1:
    ds_read_b64 v[18:19], v5 offset:8
    s_waitcnt lgkmcnt(0)
    v_and_b32 v18, v18, v19
    s_nop 0
    v_readfirstlane_b32 s30, v18
    s_nop 0
    s_cmp_eq_u32 s30, 1
    s_cbranch_scc1 KF_G1
    s_branch KF_W1
KF_G1:
    v_mfma_f32_16x16x32_bf16 v[56:59], v[104:107], v[24:27], v[56:59]
    ds_read_b128 v[40:43], v4 offset:12288
    ds_read_b128 v[44:47], v4 offset:13312
    v_mfma_f32_16x16x32_bf16 v[60:63], v[104:107], v[28:31], v[60:63]
    ds_read_b128 v[48:51], v4 offset:14336
    ds_read_b128 v[52:55], v4 offset:15360
    v_mfma_f32_16x16x32_bf16 v[64:67], v[104:107], v[32:35], v[64:67]
    v_mfma_f32_16x16x32_bf16 v[68:71], v[104:107], v[36:39], v[68:71]
    buffer_load_dwordx4 v[104:107], v3, s[8:11], s26 offen offset:0
    v_mfma_f32_16x16x32_bf16 v[72:75], v[108:111], v[24:27], v[72:75]
    v_mfma_f32_16x16x32_bf16 v[76:79], v[108:111], v[28:31], v[76:79]
    v_mfma_f32_16x16x32_bf16 v[80:83], v[108:111], v[32:35], v[80:83]
    v_mfma_f32_16x16x32_bf16 v[84:87], v[108:111], v[36:39], v[84:87]
    buffer_load_dwordx4 v[108:111], v3, s[8:11], s26 offen offset:1024
    v_mfma_f32_16x16x32_bf16 v[88:91], v[112:115], v[24:27], v[88:91]
    v_mfma_f32_16x16x32_bf16 v[92:95], v[112:115], v[28:31], v[92:95]
    v_mfma_f32_16x16x32_bf16 v[96:99], v[112:115], v[32:35], v[96:99]
    v_mfma_f32_16x16x32_bf16 v[100:103], v[112:115], v[36:39], v[100:103]
    buffer_load_dwordx4 v[112:115], v3, s[8:11], s26 offen offset:2048
    s_add_u32 s26, s26, 3072
    s_waitcnt vmcnt(12) lgkmcnt(0)
    v_mfma_f32_16x16x32_bf16 v[56:59], v[116:119], v[40:43], v[56:59]
    ds_read_b128 v[24:27], v4 offset:16384
    ds_read_b128 v[28:31], v4 offset:17408
    v_mfma_f32_16x16x32_bf16 v[60:63], v[116:119], v[44:47], v[60:63]
    ds_read_b128 v[32:35], v4 offset:18432
    ds_read_b128 v[36:39], v4 offset:19456
    v_mfma_f32_16x16x32_bf16 v[64:67], v[116:119], v[48:51], v[64:67]
    v_mfma_f32_16x16x32_bf16 v[68:71], v[116:119], v[52:55], v[68:71]
    buffer_load_dwordx4 v[116:119], v3, s[8:11], s26 offen offset:0
    v_mfma_f32_16x16x32_bf16 v[72:75], v[120:123], v[40:43], v[72:75]
    v_mfma_f32_16x16x32_bf16 v[76:79], v[120:123], v[44:47], v[76:79]
    v_mfma_f32_16x16x32_bf16 v[80:83], v[120:123], v[48:51], v[80:83]
    v_mfma_f32_16x16x32_bf16 v[84:87], v[120:123], v[52:55], v[84:87]
    buffer_load_dwordx4 v[120:123], v3, s[8:11], s26 offen offset:1024
    v_mfma_f32_16x16x32_bf16 v[88:91], v[124:127], v[40:43], v[88:91]
    v_mfma_f32_16x16x32_bf16 v[92:95], v[124:127], v[44:47], v[92:95]
    v_mfma_f32_16x16x32_bf16 v[96:99], v[124:127], v[48:51], v[96:99]
    v_mfma_f32_16x16x32_bf16 v[100:103], v[124:127], v[52:55], v[100:103]
    buffer_load_dwordx4 v[124:127], v3, s[8:11], s26 offen offset:2048
    s_add_u32 s26, s26, 3072
    s_waitcnt vmcnt(12) lgkmcnt(0)
    v_mfma_f32_16x16x32_bf16 v[56:59], v[128:131], v[24:27], v[56:59]
    ds_read_b128 v[40:43], v4 offset:20480
    ds_read_b128 v[44:47], v4 offset:21504
    v_mfma_f32_16x16x32_bf16 v[60:63], v[128:131], v[28:31], v[60:63]
    ds_read_b128 v[48:51], v4 offset:22528
    ds_read_b128 v[52:55], v4 offset:23552
    v_mfma_f32_16x16x32_bf16 v[64:67], v[128:131], v[32:35], v[64:67]
    v_mfma_f32_16x16x32_bf16 v[68:71], v[128:131], v[36:39], v[68:71]
    buffer_load_dwordx4 v[128:131], v3, s[8:11], s26 offen offset:0
    v_mfma_f32_16x16x32_bf16 v[72:75], v[132:135], v[24:27], v[72:75]
    v_mfma_f32_16x16x32_bf16 v[76:79], v[132:135], v[28:31], v[76:79]
    v_mfma_f32_16x16x32_bf16 v[80:83], v[132:135], v[32:35], v[80:83]
    v_mfma_f32_16x16x32_bf16 v[84:87], v[132:135], v[36:39], v[84:87]
    buffer_load_dwordx4 v[132:135], v3, s[8:11], s26 offen offset:1024
    v_mfma_f32_16x16x32_bf16 v[88:91], v[136:139], v[24:27], v[88:91]
    v_mfma_f32_16x16x32_bf16 v[92:95], v[136:139], v[28:31], v[92:95]
    v_mfma_f32_16x16x32_bf16 v[96:99], v[136:139], v[32:35], v[96:99]
    v_mfma_f32_16x16x32_bf16 v[100:103], v[136:139], v[36:39], v[100:103]
    buffer_load_dwordx4 v[136:139], v3, s[8:11], s26 offen offset:2048
    s_add_u32 s26, s26, 3072
    s_waitcnt vmcnt(12) lgkmcnt(0)
KF_W2:
    ds_read_b64 v[18:19], v5 offset:16
    s_waitcnt lgkmcnt(0)
    v_and_b32 v18, v18, v19
    s_nop 0
    v_readfirstlane_b32 s30, v18
    s_nop 0
    s_cmp_eq_u32 s30, 1
    s_cbranch_scc1 KF_G2
    s_branch KF_W2
KF_G2:
    v_mfma_f32_16x16x32_bf16 v[56:59], v[140:143], v[40:43], v[56:59]
    ds_read_b128 v[24:27], v4 offset:24576
    ds_read_b128 v[28:31], v4 offset:25600
    v_mfma_f32_16x16x32_bf16 v[60:63], v[140:143], v[44:47], v[60:63]
    ds_read_b128 v[32:35], v4 offset:26624
    ds_read_b128 v[36:39], v4 offset:27648
    v_mfma_f32_16x16x32_bf16 v[64:67], v[140:143], v[48:51], v[64:67]
    v_mfma_f32_16x16x32_bf16 v[68:71], v[140:143], v[52:55], v[68:71]
    buffer_load_dwordx4 v[140:143], v3, s[8:11], s26 offen offset:0
    v_mfma_f32_16x16x32_bf16 v[72:75], v[144:147], v[40:43], v[72:75]
    v_mfma_f32_16x16x32_bf16 v[76:79], v[144:147], v[44:47], v[76:79]
    v_mfma_f32_16x16x32_bf16 v[80:83], v[144:147], v[48:51], v[80:83]
    v_mfma_f32_16x16x32_bf16 v[84:87], v[144:147], v[52:55], v[84:87]
    buffer_load_dwordx4 v[144:147], v3, s[8:11], s26 offen offset:1024
    v_mfma_f32_16x16x32_bf16 v[88:91], v[148:151], v[40:43], v[88:91]
    v_mfma_f32_16x16x32_bf16 v[92:95], v[148:151], v[44:47], v[92:95]
    v_mfma_f32_16x16x32_bf16 v[96:99], v[148:151], v[48:51], v[96:99]
    v_mfma_f32_16x16x32_bf16 v[100:103], v[148:151], v[52:55], v[100:103]
    buffer_load_dwordx4 v[148:151], v3, s[8:11], s26 offen offset:2048
    s_add_u32 s26, s26, 3072
    s_waitcnt vmcnt(12) lgkmcnt(0)
    v_mfma_f32_16x16x32_bf16 v[56:59], v[152:155], v[24:27], v[56:59]
    ds_read_b128 v[40:43], v4 offset:28672
    ds_read_b128 v[44:47], v4 offset:29696
    v_mfma_f32_16x16x32_bf16 v[60:63], v[152:155], v[28:31], v[60:63]
    ds_read_b128 v[48:51], v4 offset:30720
    ds_read_b128 v[52:55], v4 offset:31744
    v_mfma_f32_16x16x32_bf16 v[64:67], v[152:155], v[32:35], v[64:67]
    v_mfma_f32_16x16x32_bf16 v[68:71], v[152:155], v[36:39], v[68:71]
    buffer_load_dwordx4 v[152:155], v3, s[8:11], s26 offen offset:0
    v_mfma_f32_16x16x32_bf16 v[72:75], v[156:159], v[24:27], v[72:75]
    v_mfma_f32_16x16x32_bf16 v[76:79], v[156:159], v[28:31], v[76:79]
    v_mfma_f32_16x16x32_bf16 v[80:83], v[156:159], v[32:35], v[80:83]
    v_mfma_f32_16x16x32_bf16 v[84:87], v[156:159], v[36:39], v[84:87]
    buffer_load_dwordx4 v[156:159], v3, s[8:11], s26 offen offset:1024
    v_mfma_f32_16x16x32_bf16 v[88:91], v[160:163], v[24:27], v[88:91]
    v_mfma_f32_16x16x32_bf16 v[92:95], v[160:163], v[28:31], v[92:95]
    v_mfma_f32_16x16x32_bf16 v[96:99], v[160:163], v[32:35], v[96:99]
    v_mfma_f32_16x16x32_bf16 v[100:103], v[160:163], v[36:39], v[100:103]
    buffer_load_dwordx4 v[160:163], v3, s[8:11], s26 offen offset:2048
    s_add_u32 s26, s26, 3072
    s_waitcnt vmcnt(12) lgkmcnt(0)
    v_mfma_f32_16x16x32_bf16 v[56:59], v[104:107], v[40:43], v[56:59]
    ds_read_b128 v[24:27], v4 offset:32768
    ds_read_b128 v[28:31], v4 offset:33792
    v_mfma_f32_16x16x32_bf16 v[60:63], v[104:107], v[44:47], v[60:63]
    ds_read_b128 v[32:35], v4 offset:34816
    ds_read_b128 v[36:39], v4 offset:35840
    v_mfma_f32_16x16x32_bf16 v[64:67], v[104:107], v[48:51], v[64:67]
    v_mfma_f32_16x16x32_bf16 v[68:71], v[104:107], v[52:55], v[68:71]
    buffer_load_dwordx4 v[104:107], v3, s[8:11], s26 offen offset:0
    v_mfma_f32_16x16x32_bf16 v[72:75], v[108:111], v[40:43], v[72:75]
    v_mfma_f32_16x16x32_bf16 v[76:79], v[108:111], v[44:47], v[76:79]
    v_mfma_f32_16x16x32_bf16 v[80:83], v[108:111], v[48:51], v[80:83]
    v_mfma_f32_16x16x32_bf16 v[84:87], v[108:111], v[52:55], v[84:87]
    buffer_load_dwordx4 v[108:111], v3, s[8:11], s26 offen offset:1024
    v_mfma_f32_16x16x32_bf16 v[88:91], v[112:115], v[40:43], v[88:91]
    v_mfma_f32_16x16x32_bf16 v[92:95], v[112:115], v[44:47], v[92:95]
    v_mfma_f32_16x16x32_bf16 v[96:99], v[112:115], v[48:51], v[96:99]
    v_mfma_f32_16x16x32_bf16 v[100:103], v[112:115], v[52:55], v[100:103]
    buffer_load_dwordx4 v[112:115], v3, s[8:11], s26 offen offset:2048
    s_add_u32 s26, s26, 3072
    s_waitcnt vmcnt(12) lgkmcnt(0)
    v_add_u32 v4, 0x9000, v4
KF_W3:
    ds_read_b64 v[18:19], v5 offset:24
    s_waitcnt lgkmcnt(0)
    v_and_b32 v18, v18, v19
    s_nop 0
    v_readfirstlane_b32 s30, v18
    s_nop 0
    s_cmp_eq_u32 s30, 1
    s_cbranch_scc1 KF_G3
    s_branch KF_W3
KF_G3:
    v_mfma_f32_16x16x32_bf16 v[56:59], v[116:119], v[24:27], v[56:59]
    ds_read_b128 v[40:43], v4 offset:0
    ds_read_b128 v[44:47], v4 offset:1024
    v_mfma_f32_16x16x32_bf16 v[60:63], v[116:119], v[28:31], v[60:63]
    ds_read_b128 v[48:51], v4 offset:2048
    ds_read_b128 v[52:55], v4 offset:3072
    v_mfma_f32_16x16x32_bf16 v[64:67], v[116:119], v[32:35], v[64:67]
    v_mfma_f32_16x16x32_bf16 v[68:71], v[116:119], v[36:39], v[68:71]
    buffer_load_dwordx4 v[116:119], v3, s[8:11], s26 offen offset:0
    v_mfma_f32_16x16x32_bf16 v[72:75], v[120:123], v[24:27], v[72:75]
    v_mfma_f32_16x16x32_bf16 v[76:79], v[120:123], v[28:31], v[76:79]
    v_mfma_f32_16x16x32_bf16 v[80:83], v[120:123], v[32:35], v[80:83]
    v_mfma_f32_16x16x32_bf16 v[84:87], v[120:123], v[36:39], v[84:87]
    buffer_load_dwordx4 v[120:123], v3, s[8:11], s26 offen offset:1024
    v_mfma_f32_16x16x32_bf16 v[88:91], v[124:127], v[24:27], v[88:91]
    v_mfma_f32_16x16x32_bf16 v[92:95], v[124:127], v[28:31], v[92:95]
    v_mfma_f32_16x16x32_bf16 v[96:99], v[124:127], v[32:35], v[96:99]
    v_mfma_f32_16x16x32_bf16 v[100:103], v[124:127], v[36:39], v[100:103]
    buffer_load_dwordx4 v[124:127], v3, s[8:11], s26 offen offset:2048
    s_add_u32 s26, s26, 3072
    s_waitcnt vmcnt(12) lgkmcnt(0)
    v_mfma_f32_16x16x32_bf16 v[56:59], v[128:131], v[40:43], v[56:59]
    ds_read_b128 v[24:27], v4 offset:4096
    ds_read_b128 v[28:31], v4 offset:5120
    v_mfma_f32_16x16x32_bf16 v[60:63], v[128:131], v[44:47], v[60:63]
    ds_read_b128 v[32:35], v4 offset:6144
    ds_read_b128 v[36:39], v4 offset:7168
    v_mfma_f32_16x16x32_bf16 v[64:67], v[128:131], v[48:51], v[64:67]
    v_mfma_f32_16x16x32_bf16 v[68:71], v[128:131], v[52:55], v[68:71]
    buffer_load_dwordx4 v[128:131], v3, s[8:11], s26 offen offset:0
    v_mfma_f32_16x16x32_bf16 v[72:75], v[132:135], v[40:43], v[72:75]
    v_mfma_f32_16x16x32_bf16 v[76:79], v[132:135], v[44:47], v[76:79]
    v_mfma_f32_16x16x32_bf16 v[80:83], v[132:135], v[48:51], v[80:83]
    v_mfma_f32_16x16x32_bf16 v[84:87], v[132:135], v[52:55], v[84:87]
    buffer_load_dwordx4 v[132:135], v3, s[8:11], s26 offen offset:1024
    v_mfma_f32_16x16x32_bf16 v[88:91], v[136:139], v[40:43], v[88:91]
    v_mfma_f32_16x16x32_bf16 v[92:95], v[136:139], v[44:47], v[92:95]
    v_mfma_f32_16x16x32_bf16 v[96:99], v[136:139], v[48:51], v[96:99]
    v_mfma_f32_16x16x32_bf16 v[100:103], v[136:139], v[52:55], v[100:103]
    buffer_load_dwordx4 v[136:139], v3, s[8:11], s26 offen offset:2048
    s_add_u32 s26, s26, 3072
    s_waitcnt vmcnt(12) lgkmcnt(0)
    v_mfma_f32_16x16x32_bf16 v[56:59], v[140:143], v[24:27], v[56:59]
    ds_read_b128 v[40:43], v4 offset:8192
    ds_read_b128 v[44:47], v4 offset:9216
    v_mfma_f32_16x16x32_bf16 v[60:63], v[140:143], v[28:31], v[60:63]
    ds_read_b128 v[48:51], v4 offset:10240
    ds_read_b128 v[52:55], v4 offset:11264
    v_mfma_f32_16x16x32_bf16 v[64:67], v[140:143], v[32:35], v[64:67]
    v_mfma_f32_16x16x32_bf16 v[68:71], v[140:143], v[36:39], v[68:71]
    buffer_load_dwordx4 v[140:143], v3, s[8:11], s26 offen offset:0
    v_mfma_f32_16x16x32_bf16 v[72:75], v[144:147], v[24:27], v[72:75]
    v_mfma_f32_16x16x32_bf16 v[76:79], v[144:147], v[28:31], v[76:79]
    v_mfma_f32_16x16x32_bf16 v[80:83], v[144:147], v[32:35], v[80:83]
    v_mfma_f32_16x16x32_bf16 v[84:87], v[144:147], v[36:39], v[84:87]
    buffer_load_dwordx4 v[144:147], v3, s[8:11], s26 offen offset:1024
    v_mfma_f32_16x16x32_bf16 v[88:91], v[148:151], v[24:27], v[88:91]
    v_mfma_f32_16x16x32_bf16 v[92:95], v[148:151], v[28:31], v[92:95]
    v_mfma_f32_16x16x32_bf16 v[96:99], v[148:151], v[32:35], v[96:99]
    v_mfma_f32_16x16x32_bf16 v[100:103], v[148:151], v[36:39], v[100:103]
    buffer_load_dwordx4 v[148:151], v3, s[8:11], s26 offen offset:2048
    s_add_u32 s26, s26, 3072
    s_waitcnt vmcnt(12) lgkmcnt(0)
KF_W4:
    ds_read_b64 v[18:19], v5 offset:32
    s_waitcnt lgkmcnt(0)
    v_and_b32 v18, v18, v19
    s_nop 0
    v_readfirstlane_b32 s30, v18
    s_nop 0
    s_cmp_eq_u32 s30, 1
    s_cbranch_scc1 KF_G4
    s_branch KF_W4
KF_G4:
    v_mfma_f32_16x16x32_bf16 v[56:59], v[152:155], v[40:43], v[56:59]
    ds_read_b128 v[24:27], v4 offset:12288
    ds_read_b128 v[28:31], v4 offset:13312
    v_mfma_f32_16x16x32_bf16 v[60:63], v[152:155], v[44:47], v[60:63]
    ds_read_b128 v[32:35], v4 offset:14336
    ds_read_b128 v[36:39], v4 offset:15360
    v_mfma_f32_16x16x32_bf16 v[64:67], v[152:155], v[48:51], v[64:67]
    v_mfma_f32_16x16x32_bf16 v[68:71], v[152:155], v[52:55], v[68:71]
    buffer_load_dwordx4 v[152:155], v3, s[8:11], s26 offen offset:0
    v_mfma_f32_16x16x32_bf16 v[72:75], v[156:159], v[40:43], v[72:75]
    v_mfma_f32_16x16x32_bf16 v[76:79], v[156:159], v[44:47], v[76:79]
    v_mfma_f32_16x16x32_bf16 v[80:83], v[156:159], v[48:51], v[80:83]
    v_mfma_f32_16x16x32_bf16 v[84:87], v[156:159], v[52:55], v[84:87]
    buffer_load_dwordx4 v[156:159], v3, s[8:11], s26 offen offset:1024
    v_mfma_f32_16x16x32_bf16 v[88:91], v[160:163], v[40:43], v[88:91]
    v_mfma_f32_16x16x32_bf16 v[92:95], v[160:163], v[44:47], v[92:95]
    v_mfma_f32_16x16x32_bf16 v[96:99], v[160:163], v[48:51], v[96:99]
    v_mfma_f32_16x16x32_bf16 v[100:103], v[160:163], v[52:55], v[100:103]
    buffer_load_dwordx4 v[160:163], v3, s[8:11], s26 offen offset:2048
    s_add_u32 s26, s26, 3072
    s_waitcnt vmcnt(12) lgkmcnt(0)
    v_mfma_f32_16x16x32_bf16 v[56:59], v[104:107], v[24:27], v[56:59]
    ds_read_b128 v[40:43], v4 offset:16384
    ds_read_b128 v[44:47], v4 offset:17408
    v_mfma_f32_16x16x32_bf16 v[60:63], v[104:107], v[28:31], v[60:63]
    ds_read_b128 v[48:51], v4 offset:18432
    ds_read_b128 v[52:55], v4 offset:19456
    v_mfma_f32_16x16x32_bf16 v[64:67], v[104:107], v[32:35], v[64:67]
    v_mfma_f32_16x16x32_bf16 v[68:71], v[104:107], v[36:39], v[68:71]
    buffer_load_dwordx4 v[104:107], v3, s[8:11], s26 offen offset:0
    v_mfma_f32_16x16x32_bf16 v[72:75], v[108:111], v[24:27], v[72:75]
    v_mfma_f32_16x16x32_bf16 v[76:79], v[108:111], v[28:31], v[76:79]
    v_mfma_f32_16x16x32_bf16 v[80:83], v[108:111], v[32:35], v[80:83]
    v_mfma_f32_16x16x32_bf16 v[84:87], v[108:111], v[36:39], v[84:87]
    buffer_load_dwordx4 v[108:111], v3, s[8:11], s26 offen offset:1024
    v_mfma_f32_16x16x32_bf16 v[88:91], v[112:115], v[24:27], v[88:91]
    v_mfma_f32_16x16x32_bf16 v[92:95], v[112:115], v[28:31], v[92:95]
    v_mfma_f32_16x16x32_bf16 v[96:99], v[112:115], v[32:35], v[96:99]
    v_mfma_f32_16x16x32_bf16 v[100:103], v[112:115], v[36:39], v[100:103]
    buffer_load_dwordx4 v[112:115], v3, s[8:11], s26 offen offset:2048
    s_add_u32 s26, s26, 3072
    s_waitcnt vmcnt(12) lgkmcnt(0)
    v_mfma_f32_16x16x32_bf16 v[56:59], v[116:119], v[40:43], v[56:59]
    ds_read_b128 v[24:27], v4 offset:20480
    ds_read_b128 v[28:31], v4 offset:21504
    v_mfma_f32_16x16x32_bf16 v[60:63], v[116:119], v[44:47], v[60:63]
    ds_read_b128 v[32:35], v4 offset:22528
    ds_read_b128 v[36:39], v4 offset:23552
    v_mfma_f32_16x16x32_bf16 v[64:67], v[116:119], v[48:51], v[64:67]
    v_mfma_f32_16x16x32_bf16 v[68:71], v[116:119], v[52:55], v[68:71]
    v_mfma_f32_16x16x32_bf16 v[72:75], v[120:123], v[40:43], v[72:75]
    v_mfma_f32_16x16x32_bf16 v[76:79], v[120:123], v[44:47], v[76:79]
    v_mfma_f32_16x16x32_bf16 v[80:83], v[120:123], v[48:51], v[80:83]
    v_mfma_f32_16x16x32_bf16 v[84:87], v[120:123], v[52:55], v[84:87]
    v_mfma_f32_16x16x32_bf16 v[88:91], v[124:127], v[40:43], v[88:91]
    v_mfma_f32_16x16x32_bf16 v[92:95], v[124:127], v[44:47], v[92:95]
    v_mfma_f32_16x16x32_bf16 v[96:99], v[124:127], v[48:51], v[96:99]
    v_mfma_f32_16x16x32_bf16 v[100:103], v[124:127], v[52:55], v[100:103]
    s_waitcnt vmcnt(9) lgkmcnt(0)
KF_W5:
    ds_read_b64 v[18:19], v5 offset:40
    s_waitcnt lgkmcnt(0)
    v_and_b32 v18, v18, v19
    s_nop 0
    v_readfirstlane_b32 s30, v18
    s_nop 0
    s_cmp_eq_u32 s30, 1
    s_cbranch_scc1 KF_G5
    s_branch KF_W5
KF_G5:
    v_mfma_f32_16x16x32_bf16 v[56:59], v[128:131], v[24:27], v[56:59]
    ds_read_b128 v[40:43], v4 offset:24576
    ds_read_b128 v[44:47], v4 offset:25600
    v_mfma_f32_16x16x32_bf16 v[60:63], v[128:131], v[28:31], v[60:63]
    ds_read_b128 v[48:51], v4 offset:26624
    ds_read_b128 v[52:55], v4 offset:27648
    v_mfma_f32_16x16x32_bf16 v[64:67], v[128:131], v[32:35], v[64:67]
    v_mfma_f32_16x16x32_bf16 v[68:71], v[128:131], v[36:39], v[68:71]
    v_mfma_f32_16x16x32_bf16 v[72:75], v[132:135], v[24:27], v[72:75]
    v_mfma_f32_16x16x32_bf16 v[76:79], v[132:135], v[28:31], v[76:79]
    v_mfma_f32_16x16x32_bf16 v[80:83], v[132:135], v[32:35], v[80:83]
    v_mfma_f32_16x16x32_bf16 v[84:87], v[132:135], v[36:39], v[84:87]
    v_mfma_f32_16x16x32_bf16 v[88:91], v[136:139], v[24:27], v[88:91]
    v_mfma_f32_16x16x32_bf16 v[92:95], v[136:139], v[28:31], v[92:95]
    v_mfma_f32_16x16x32_bf16 v[96:99], v[136:139], v[32:35], v[96:99]
    v_mfma_f32_16x16x32_bf16 v[100:103], v[136:139], v[36:39], v[100:103]
    s_waitcnt vmcnt(6) lgkmcnt(0)
    v_mfma_f32_16x16x32_bf16 v[56:59], v[140:143], v[40:43], v[56:59]
    ds_read_b128 v[24:27], v4 offset:28672
    ds_read_b128 v[28:31], v4 offset:29696
    v_mfma_f32_16x16x32_bf16 v[60:63], v[140:143], v[44:47], v[60:63]
    ds_read_b128 v[32:35], v4 offset:30720
    ds_read_b128 v[36:39], v4 offset:31744
    v_mfma_f32_16x16x32_bf16 v[64:67], v[140:143], v[48:51], v[64:67]
    v_mfma_f32_16x16x32_bf16 v[68:71], v[140:143], v[52:55], v[68:71]
    v_mfma_f32_16x16x32_bf16 v[72:75], v[144:147], v[40:43], v[72:75]
    v_mfma_f32_16x16x32_bf16 v[76:79], v[144:147], v[44:47], v[76:79]
    v_mfma_f32_16x16x32_bf16 v[80:83], v[144:147], v[48:51], v[80:83]
    v_mfma_f32_16x16x32_bf16 v[84:87], v[144:147], v[52:55], v[84:87]
    v_mfma_f32_16x16x32_bf16 v[88:91], v[148:151], v[40:43], v[88:91]
    v_mfma_f32_16x16x32_bf16 v[92:95], v[148:151], v[44:47], v[92:95]
    v_mfma_f32_16x16x32_bf16 v[96:99], v[148:151], v[48:51], v[96:99]
    v_mfma_f32_16x16x32_bf16 v[100:103], v[148:151], v[52:55], v[100:103]
    s_waitcnt vmcnt(3) lgkmcnt(0)
    v_mfma_f32_16x16x32_bf16 v[56:59], v[152:155], v[24:27], v[56:59]
    ds_read_b128 v[40:43], v4 offset:32768
    ds_read_b128 v[44:47], v4 offset:33792
    v_mfma_f32_16x16x32_bf16 v[60:63], v[152:155], v[28:31], v[60:63]
    ds_read_b128 v[48:51], v4 offset:34816
    ds_read_b128 v[52:55], v4 offset:35840
    v_mfma_f32_16x16x32_bf16 v[64:67], v[152:155], v[32:35], v[64:67]
    v_mfma_f32_16x16x32_bf16 v[68:71], v[152:155], v[36:39], v[68:71]
    v_mfma_f32_16x16x32_bf16 v[72:75], v[156:159], v[24:27], v[72:75]
    v_mfma_f32_16x16x32_bf16 v[76:79], v[156:159], v[28:31], v[76:79]
    v_mfma_f32_16x16x32_bf16 v[80:83], v[156:159], v[32:35], v[80:83]
    v_mfma_f32_16x16x32_bf16 v[84:87], v[156:159], v[36:39], v[84:87]
    v_mfma_f32_16x16x32_bf16 v[88:91], v[160:163], v[24:27], v[88:91]
    v_mfma_f32_16x16x32_bf16 v[92:95], v[160:163], v[28:31], v[92:95]
    v_mfma_f32_16x16x32_bf16 v[96:99], v[160:163], v[32:35], v[96:99]
    v_mfma_f32_16x16x32_bf16 v[100:103], v[160:163], v[36:39], v[100:103]
    s_waitcnt vmcnt(0) lgkmcnt(0)
    v_mfma_f32_16x16x32_bf16 v[56:59], v[104:107], v[40:43], v[56:59]
    v_mfma_f32_16x16x32_bf16 v[60:63], v[104:107], v[44:47], v[60:63]
    v_mfma_f32_16x16x32_bf16 v[64:67], v[104:107], v[48:51], v[64:67]
    v_mfma_f32_16x16x32_bf16 v[68:71], v[104:107], v[52:55], v[68:71]
    v_mfma_f32_16x16x32_bf16 v[72:75], v[108:111], v[40:43], v[72:75]
    v_mfma_f32_16x16x32_bf16 v[76:79], v[108:111], v[44:47], v[76:79]
    v_mfma_f32_16x16x32_bf16 v[80:83], v[108:111], v[48:51], v[80:83]
    v_mfma_f32_16x16x32_bf16 v[84:87], v[108:111], v[52:55], v[84:87]
    v_mfma_f32_16x16x32_bf16 v[88:91], v[112:115], v[40:43], v[88:91]
    v_mfma_f32_16x16x32_bf16 v[92:95], v[112:115], v[44:47], v[92:95]
    v_mfma_f32_16x16x32_bf16 v[96:99], v[112:115], v[48:51], v[96:99]
    v_mfma_f32_16x16x32_bf16 v[100:103], v[112:115], v[52:55], v[100:103]
    v_cvt_pk_bf16_f32 v56, v56, v57
    v_cvt_pk_bf16_f32 v57, v58, v59
    v_cvt_pk_bf16_f32 v58, v60, v61
    v_cvt_pk_bf16_f32 v59, v62, v63
    buffer_store_dwordx4 v[56:59], v3, s[16:19], s34 offen offset:0 sc1
    v_cvt_pk_bf16_f32 v64, v64, v65
    v_cvt_pk_bf16_f32 v65, v66, v67
    v_cvt_pk_bf16_f32 v66, v68, v69
    v_cvt_pk_bf16_f32 v67, v70, v71
    buffer_store_dwordx4 v[64:67], v3, s[16:19], s34 offen offset:1024 sc1
    v_cvt_pk_bf16_f32 v72, v72, v73
    v_cvt_pk_bf16_f32 v73, v74, v75
    v_cvt_pk_bf16_f32 v74, v76, v77
    v_cvt_pk_bf16_f32 v75, v78, v79
    buffer_store_dwordx4 v[72:75], v3, s[16:19], s34 offen offset:2048 sc1
    v_cvt_pk_bf16_f32 v80, v80, v81
    v_cvt_pk_bf16_f32 v81, v82, v83
    v_cvt_pk_bf16_f32 v82, v84, v85
    v_cvt_pk_bf16_f32 v83, v86, v87
    buffer_store_dwordx4 v[80:83], v3, s[16:19], s34 offen offset:3072 sc1
    v_cvt_pk_bf16_f32 v88, v88, v89
    v_cvt_pk_bf16_f32 v89, v90, v91
    v_cvt_pk_bf16_f32 v90, v92, v93
    v_cvt_pk_bf16_f32 v91, v94, v95
    buffer_store_dwordx4 v[88:91], v3, s[16:19], s35 offen offset:0 sc1
    v_cvt_pk_bf16_f32 v96, v96, v97
    v_cvt_pk_bf16_f32 v97, v98, v99
    v_cvt_pk_bf16_f32 v98, v100, v101
    v_cvt_pk_bf16_f32 v99, v102, v103
    buffer_store_dwordx4 v[96:99], v3, s[16:19], s35 offen offset:1024 sc1
KF_END:
    s_endpgm

.globl k4_kernel
.p2align 8
.type k4_kernel,@function
k4_kernel:
    s_cmp_ge_u32 s2, 576
    s_cbranch_scc1 K5_END
    s_load_dwordx2 s[4:5], s[0:1], 112
    s_load_dwordx2 s[6:7], s[0:1], 96
    v_and_b32 v1, 63, v0
    v_lshrrev_b32 v2, 6, v0
    s_nop 0
    v_readfirstlane_b32 s22, v2
    v_lshlrev_b32 v3, 4, v1
    s_and_b32 s20, s2, 7
    s_mul_i32 s20, s20, 72
    s_lshr_b32 s21, s2, 3
    s_add_u32 s20, s20, s21
    s_lshl_b32 s20, s20, 2
    s_add_u32 s20, s20, s22
    s_and_b32 s21, s20, 1
    s_lshr_b32 s23, s20, 1
    s_mul_i32 s24, s23, 1821
    s_lshr_b32 s24, s24, 16
    s_mul_i32 s25, s24, 36
    s_sub_u32 s25, s23, s25
    s_lshl_b32 s26, s20, 10
    v_and_b32 v4, 15, v1
    v_lshrrev_b32 v5, 4, v1
    v_lshlrev_b32 v6, 9, v5
    v_lshl_add_u32 v6, v4, 1, v6
    s_mul_i32 s27, s24, 73728
    s_lshl_b32 s28, s25, 11
    s_add_u32 s27, s27, s28
    s_lshl_b32 s28, s21, 6
    s_add_u32 s27, s27, s28
    v_lshlrev_b32 v7, 4, v5
    s_lshl_b32 s29, s25, 6
    s_add_u32 s29, s29, 11520
    s_waitcnt lgkmcnt(0)
    s_add_u32 s8, s4, 0x2000000
    s_addc_u32 s9, s5, 0
    s_mov_b32 s10, 0x1200000
    s_mov_b32 s11, 0x00020000
    s_add_u32 s30, s26, 0
    buffer_load_dwordx4 v[16:19], v3, s[8:11], s30 offen
    s_add_u32 s30, s26, 2359296
    buffer_load_dwordx4 v[20:23], v3, s[8:11], s30 offen
    s_add_u32 s30, s26, 4718592
    buffer_load_dwordx4 v[24:27], v3, s[8:11], s30 offen
    s_add_u32 s30, s26, 7077888
    buffer_load_dwordx4 v[28:31], v3, s[8:11], s30 offen
    s_add_u32 s30, s26, 9437184
    buffer_load_dwordx4 v[32:35], v3, s[8:11], s30 offen
    s_add_u32 s30, s26, 11796480
    buffer_load_dwordx4 v[36:39], v3, s[8:11], s30 offen
    s_add_u32 s30, s26, 14155776
    buffer_load_dwordx4 v[40:43], v3, s[8:11], s30 offen
    s_add_u32 s30, s26, 16515072
    buffer_load_dwordx4 v[44:47], v3, s[8:11], s30 offen
    s_add_u32 s16, s4, 0xc00000
    s_addc_u32 s17, s5, 0
    s_mov_b32 s18, 0x240000
    s_mov_b32 s19, 0x00020000
    buffer_load_ushort v8, v6, s[16:19], s27 offen offset:0
    buffer_load_ushort v9, v6, s[16:19], s27 offen offset:128
    buffer_load_ushort v10, v6, s[16:19], s27 offen offset:256
    buffer_load_ushort v11, v6, s[16:19], s27 offen offset:384
    buffer_load_ushort v12, v6, s[16:19], s27 offen offset:32
    buffer_load_ushort v13, v6, s[16:19], s27 offen offset:160
    buffer_load_ushort v14, v6, s[16:19], s27 offen offset:288
    buffer_load_ushort v15, v6, s[16:19], s27 offen offset:416
    s_mov_b32 s52, s4
    s_mov_b32 s53, s5
    s_mov_b32 s54, 0x3600
    s_mov_b32 s55, 0x00020000
    buffer_load_dwordx4 v[48:51], v7, s[52:55], s29 offen
    s_mov_b32 s56, s6
    s_mov_b32 s57, s7
    s_mov_b32 s58, 0x240000
    s_mov_b32 s59, 0x00020000
    s_lshl_b32 s27, s24, 6
    s_lshl_b32 s28, s21, 5
    s_add_u32 s27, s27, s28
    v_add_u32 v52, s27, v4
    v_mul_u32_u24 v52, 1152, v52
    v_lshl_add_u32 v52, v5, 3, v52
    s_lshl_b32 s28, s25, 5
    s_add_u32 s31, s28, 18432
    s_waitcnt vmcnt(16)
    v_lshlrev_b32 v56, 16, v16
    v_and_b32 v57, 0xffff0000, v16
    v_lshlrev_b32 v58, 16, v17
    v_and_b32 v59, 0xffff0000, v17
    v_lshlrev_b32 v60, 16, v18
    v_and_b32 v61, 0xffff0000, v18
    v_lshlrev_b32 v62, 16, v19
    v_and_b32 v63, 0xffff0000, v19
    s_waitcnt vmcnt(15)
    v_lshlrev_b32 v64, 16, v20
    v_and_b32 v65, 0xffff0000, v20
    v_pk_add_f32 v[56:57], v[56:57], v[64:65]
    v_lshlrev_b32 v66, 16, v21
    v_and_b32 v67, 0xffff0000, v21
    v_pk_add_f32 v[58:59], v[58:59], v[66:67]
    v_lshlrev_b32 v68, 16, v22
    v_and_b32 v69, 0xffff0000, v22
    v_pk_add_f32 v[60:61], v[60:61], v[68:69]
    v_lshlrev_b32 v70, 16, v23
    v_and_b32 v71, 0xffff0000, v23
    v_pk_add_f32 v[62:63], v[62:63], v[70:71]
    s_waitcnt vmcnt(14)
    v_lshlrev_b32 v64, 16, v24
    v_and_b32 v65, 0xffff0000, v24
    v_pk_add_f32 v[56:57], v[56:57], v[64:65]
    v_lshlrev_b32 v66, 16, v25
    v_and_b32 v67, 0xffff0000, v25
    v_pk_add_f32 v[58:59], v[58:59], v[66:67]
    v_lshlrev_b32 v68, 16, v26
    v_and_b32 v69, 0xffff0000, v26
    v_pk_add_f32 v[60:61], v[60:61], v[68:69]
    v_lshlrev_b32 v70, 16, v27
    v_and_b32 v71, 0xffff0000, v27
    v_pk_add_f32 v[62:63], v[62:63], v[70:71]
    s_waitcnt vmcnt(13)
    v_lshlrev_b32 v64, 16, v28
    v_and_b32 v65, 0xffff0000, v28
    v_pk_add_f32 v[56:57], v[56:57], v[64:65]
    v_lshlrev_b32 v66, 16, v29
    v_and_b32 v67, 0xffff0000, v29
    v_pk_add_f32 v[58:59], v[58:59], v[66:67]
    v_lshlrev_b32 v68, 16, v30
    v_and_b32 v69, 0xffff0000, v30
    v_pk_add_f32 v[60:61], v[60:61], v[68:69]
    v_lshlrev_b32 v70, 16, v31
    v_and_b32 v71, 0xffff0000, v31
    v_pk_add_f32 v[62:63], v[62:63], v[70:71]
    s_waitcnt vmcnt(12)
    v_lshlrev_b32 v64, 16, v32
    v_and_b32 v65, 0xffff0000, v32
    v_pk_add_f32 v[56:57], v[56:57], v[64:65]
    v_lshlrev_b32 v66, 16, v33
    v_and_b32 v67, 0xffff0000, v33
    v_pk_add_f32 v[58:59], v[58:59], v[66:67]
    v_lshlrev_b32 v68, 16, v34
    v_and_b32 v69, 0xffff0000, v34
    v_pk_add_f32 v[60:61], v[60:61], v[68:69]
    v_lshlrev_b32 v70, 16, v35
    v_and_b32 v71, 0xffff0000, v35
    v_pk_add_f32 v[62:63], v[62:63], v[70:71]
    s_waitcnt vmcnt(11)
    v_lshlrev_b32 v64, 16, v36
    v_and_b32 v65, 0xffff0000, v36
    v_pk_add_f32 v[56:57], v[56:57], v[64:65]
    v_lshlrev_b32 v66, 16, v37
    v_and_b32 v67, 0xffff0000, v37
    v_pk_add_f32 v[58:59], v[58:59], v[66:67]
    v_lshlrev_b32 v68, 16, v38
    v_and_b32 v69, 0xffff0000, v38
    v_pk_add_f32 v[60:61], v[60:61], v[68:69]
    v_lshlrev_b32 v70, 16, v39
    v_and_b32 v71, 0xffff0000, v39
    v_pk_add_f32 v[62:63], v[62:63], v[70:71]
    s_waitcnt vmcnt(10)
    v_lshlrev_b32 v64, 16, v40
    v_and_b32 v65, 0xffff0000, v40
    v_pk_add_f32 v[56:57], v[56:57], v[64:65]
    v_lshlrev_b32 v66, 16, v41
    v_and_b32 v67, 0xffff0000, v41
    v_pk_add_f32 v[58:59], v[58:59], v[66:67]
    v_lshlrev_b32 v68, 16, v42
    v_and_b32 v69, 0xffff0000, v42
    v_pk_add_f32 v[60:61], v[60:61], v[68:69]
    v_lshlrev_b32 v70, 16, v43
    v_and_b32 v71, 0xffff0000, v43
    v_pk_add_f32 v[62:63], v[62:63], v[70:71]
    s_waitcnt vmcnt(9)
    v_lshlrev_b32 v64, 16, v44
    v_and_b32 v65, 0xffff0000, v44
    v_pk_add_f32 v[56:57], v[56:57], v[64:65]
    v_lshlrev_b32 v66, 16, v45
    v_and_b32 v67, 0xffff0000, v45
    v_pk_add_f32 v[58:59], v[58:59], v[66:67]
    v_lshlrev_b32 v68, 16, v46
    v_and_b32 v69, 0xffff0000, v46
    v_pk_add_f32 v[60:61], v[60:61], v[68:69]
    v_lshlrev_b32 v70, 16, v47
    v_and_b32 v71, 0xffff0000, v47
    v_pk_add_f32 v[62:63], v[62:63], v[70:71]
    v_mul_f32 v56, 0xbf317218, v56
    v_mul_f32 v57, 0xbf317218, v57
    v_mul_f32 v58, 0xbf317218, v58
    v_mul_f32 v59, 0xbf317218, v59
    v_mul_f32 v60, 0xbf317218, v60
    v_mul_f32 v61, 0xbf317218, v61
    v_mul_f32 v62, 0xbf317218, v62
    v_mul_f32 v63, 0xbf317218, v63
    v_cvt_pk_bf16_f32 v16, v56, v57
    v_cvt_pk_bf16_f32 v17, v58, v59
    v_cvt_pk_bf16_f32 v18, v60, v61
    v_cvt_pk_bf16_f32 v19, v62, v63
    v_lshlrev_b32 v56, 16, v16
    v_and_b32 v57, 0xffff0000, v16
    v_lshlrev_b32 v58, 16, v17
    v_and_b32 v59, 0xffff0000, v17
    v_lshlrev_b32 v60, 16, v18
    v_and_b32 v61, 0xffff0000, v18
    v_lshlrev_b32 v62, 16, v19
    v_and_b32 v63, 0xffff0000, v19
    s_waitcnt vmcnt(0)
    v_pk_mul_f32 v[56:57], v[56:57], v[48:49]
    v_pk_mul_f32 v[58:59], v[58:59], v[50:51]
    v_pk_mul_f32 v[60:61], v[60:61], v[48:49]
    v_pk_mul_f32 v[62:63], v[62:63], v[50:51]
    v_cvt_pk_bf16_f32 v16, v56, v57
    v_cvt_pk_bf16_f32 v17, v58, v59
    v_cvt_pk_bf16_f32 v18, v60, v61
    v_cvt_pk_bf16_f32 v19, v62, v63
    v_lshlrev_b32 v56, 16, v16
    v_and_b32 v57, 0xffff0000, v16
    v_lshlrev_b32 v58, 16, v17
    v_and_b32 v59, 0xffff0000, v17
    v_lshlrev_b32 v60, 16, v18
    v_and_b32 v61, 0xffff0000, v18
    v_lshlrev_b32 v62, 16, v19
    v_and_b32 v63, 0xffff0000, v19
    v_lshlrev_b32 v8, 16, v8
    v_lshlrev_b32 v9, 16, v9
    v_lshlrev_b32 v10, 16, v10
    v_lshlrev_b32 v11, 16, v11
    v_lshlrev_b32 v12, 16, v12
    v_lshlrev_b32 v13, 16, v13
    v_lshlrev_b32 v14, 16, v14
    v_lshlrev_b32 v15, 16, v15
    v_pk_add_f32 v[56:57], v[56:57], v[8:9]
    v_pk_add_f32 v[58:59], v[58:59], v[10:11]
    v_pk_add_f32 v[60:61], v[60:61], v[12:13]
    v_pk_add_f32 v[62:63], v[62:63], v[14:15]
    v_cvt_pk_bf16_f32 v16, v56, v57
    v_cvt_pk_bf16_f32 v17, v58, v59
    v_cvt_pk_bf16_f32 v18, v60, v61
    v_cvt_pk_bf16_f32 v19, v62, v63
    buffer_store_dwordx2 v[16:17], v52, s[56:59], s28 offen
    buffer_store_dwordx2 v[18:19], v52, s[56:59], s31 offen
K5_END:
    s_endpgm

CODE_END:
.section .rodata,"a"
.p2align 6
.amdhsa_kernel k1_kernel
  .amdhsa_next_free_vgpr 128
  .amdhsa_next_free_sgpr 102
  .amdhsa_accum_offset 128
  .amdhsa_group_segment_fixed_size 0
  .amdhsa_kernarg_size 120
  .amdhsa_user_sgpr_count 2
  .amdhsa_user_sgpr_kernarg_segment_ptr 1
  .amdhsa_system_sgpr_workgroup_id_x 1
.end_amdhsa_kernel

.section .rodata,"a"
.p2align 6
.amdhsa_kernel k2_kernel
  .amdhsa_next_free_vgpr 128
  .amdhsa_next_free_sgpr 102
  .amdhsa_accum_offset 128
  .amdhsa_group_segment_fixed_size 0
  .amdhsa_kernarg_size 120
  .amdhsa_user_sgpr_count 2
  .amdhsa_user_sgpr_kernarg_segment_ptr 1
  .amdhsa_system_sgpr_workgroup_id_x 1
.end_amdhsa_kernel

.section .rodata,"a"
.p2align 6
.amdhsa_kernel k3_kernel
  .amdhsa_next_free_vgpr 164
  .amdhsa_next_free_sgpr 102
  .amdhsa_accum_offset 164
  .amdhsa_group_segment_fixed_size 0
  .amdhsa_kernarg_size 120
  .amdhsa_user_sgpr_count 2
  .amdhsa_user_sgpr_kernarg_segment_ptr 1
  .amdhsa_system_sgpr_workgroup_id_x 1
.end_amdhsa_kernel

.section .rodata,"a"
.p2align 6
.amdhsa_kernel k4_kernel
  .amdhsa_next_free_vgpr 72
  .amdhsa_next_free_sgpr 102
  .amdhsa_accum_offset 72
  .amdhsa_group_segment_fixed_size 0
  .amdhsa_kernarg_size 120
  .amdhsa_user_sgpr_count 2
  .amdhsa_user_sgpr_kernarg_segment_ptr 1
  .amdhsa_system_sgpr_workgroup_id_x 1
.end_amdhsa_kernel
```
